```python
import torch

def _softmax(x, axis=-1):
    return torch.softmax(x, dim=axis)
def _gelu(x):
    return torch.nn.functional.gelu(x, approximate="tanh")
def _silu(x):
    return torch.nn.functional.silu(x)
def _sigmoid(x):
    return torch.sigmoid(x)
def _layernorm(x, axis=-1, eps=1e-5):
    m = x.mean(dim=axis, keepdim=True)
    v = x.var(dim=axis, keepdim=True, unbiased=False)
    return (x - m) / torch.sqrt(v + eps)
def _scatter_add(tgt, idx, src, axis=0):
    return tgt.clone().index_add_(axis, idx, src)
def _segment_sum(src, seg, n):
    out = torch.zeros((n,) + src.shape[1:], dtype=src.dtype)
    return out.index_add_(0, seg, src)
def _pad(x, pw):
    flat = tuple(v for pair in reversed(pw) for v in pair)
    return torch.nn.functional.pad(x, flat)

kernel_name = 'gather_scatter__cheap_equivariant_egnn__graph'

def setup_inputs():

    _w = (lambda a: (lambda t: t.to(torch.bfloat16) if t.is_floating_point() else t)(torch.as_tensor(a)))
    N, deg, D, De = 25000, 32, 64, max(16, 1)
    E = N * deg
    return {
        "h": _w((lambda *s: torch.randn(*s, dtype=torch.bfloat16) * 0.2)(N, D)),
        "pos": _w((lambda *s: torch.randn(*s, dtype=torch.bfloat16) * 0.8)(N, 3)),
        "e_attr": _w((lambda *s: torch.randn(*s, dtype=torch.bfloat16) * 0.8)(E, De)),
        "src": _w((lambda lo, hi, *s: torch.randint(lo, hi, s))(0, N, E).to(torch.int64)),
        "dst": _w((lambda lo, hi, *s: torch.randint(lo, hi, s))(0, N, E).to(torch.int64)),
        "w_e": _w(0.1 * (lambda *s: torch.randn(*s, dtype=torch.bfloat16) * 0.8)(2 * D + 1 + De, D)),
        "w_x": _w(0.1 * (lambda *s: torch.randn(*s, dtype=torch.bfloat16) * 0.2)(D, 1)),
        "w_h": _w(0.1 * (lambda *s: torch.randn(*s, dtype=torch.bfloat16) * 0.2)(2 * D, D)),
    }

def reference(h, pos, e_attr, src, dst, w_e, w_x, w_h):
    N, D = h.shape[0], h.shape[1]
    diff = pos[dst] - pos[src]
    dist2 = torch.sum(diff * diff, axis=-1, keepdims=True)
    e_in = torch.concatenate([h[dst], h[src], dist2, e_attr], axis=-1)
    m_ij = _silu(e_in @ w_e)
    coord_scale = m_ij @ w_x
    pos_new = pos + _segment_sum(diff * coord_scale, dst, N)
    m_i = _segment_sum(m_ij, dst, N)
    h_new = h + _silu(torch.concatenate([h, m_i], axis=-1) @ w_h)
    return h_new, pos_new
```

```asm
; @launch kernel=egnn_part_kernel grid=(256,1,1) block=(1024,1,1) lds=44032
; @launch kernel=egnn_main_kernel grid=(256,1,1) block=(1024,1,1) lds=163584
.amdgcn_target "amdgcn-amd-amdhsa--gfx950"
.text
.globl egnn_part_kernel
.p2align 8
.type egnn_part_kernel,@function
egnn_part_kernel:
  s_cmp_ge_u32 s2, 256
  s_cbranch_scc1 K1_END
  s_load_dwordx4 s[8:11], s[0:1], 24
  s_load_dwordx4 s[12:15], s[0:1], 40
  s_load_dwordx4 s[4:7], s[0:1], 0
  s_load_dwordx2 s[16:17], s[0:1], 56
  s_load_dwordx2 s[18:19], s[0:1], 80
  v_add_u32 v0, 832, v0
  v_and_b32 v0, 0x3ff, v0
  v_lshrrev_b32 v1, 6, v0
  v_and_b32 v2, 63, v0
  v_readfirstlane_b32 s64, v1
  v_lshlrev_b32 v3, 4, v0
  s_mul_i32 s67, s2, 3128
  s_sub_u32 s65, 800000, s67
  s_min_u32 s65, s65, 3128
  s_mul_i32 s68, s2, 98
  s_sub_u32 s66, 25000, s68
  s_min_u32 s66, s66, 98
  s_lshl_b32 s69, s67, 2
  s_lshl_b32 s70, s65, 2
  s_and_b32 s88, s2, 7
  s_lshl_b32 s88, s88, 1
  s_lshr_b32 s89, s2, 7
  s_add_u32 s88, s88, s89
  s_bfe_u32 s89, s2, 0x40003
  s_cmp_ge_u32 s64, 13
  s_waitcnt lgkmcnt(0)
  s_cbranch_scc1 K1_G0
  s_add_u32 s20, s10, s69
  s_addc_u32 s21, s11, 0
  s_mov_b32 s22, s70
  s_mov_b32 s23, 0x20000
  buffer_load_dwordx4 v[8:11], v3, s[20:23], 0 offen
  s_add_u32 s24, s8, s69
  s_addc_u32 s25, s9, 0
  s_mov_b32 s26, s70
  s_mov_b32 s27, 0x20000
  buffer_load_dwordx4 v[12:15], v3, s[24:27], 0 offen
  v_mov_b32 v20, 0
  s_cmp_ge_u32 s64, 8
  s_cbranch_scc1 K1_NOZ
  v_lshlrev_b32 v21, 2, v0
  ds_write_b32 v21, v20 offset:0
K1_NOZ:
  s_lshl_b32 s69, s67, 3
  s_add_u32 s69, s69, 0x3ff80
  s_lshl_b32 s70, s65, 3
  s_add_u32 s70, s70, 128
  s_add_u32 s40, s18, s69
  s_addc_u32 s41, s19, 0
  s_mov_b32 s42, s70
  s_mov_b32 s43, 0x20000
  s_add_u32 s44, s18, 0x1400000
  s_addc_u32 s45, s19, 0
  s_mov_b32 s46, 524288
  s_mov_b32 s47, 0x20000
  s_add_u32 s76, s18, 0xc00000
  s_addc_u32 s77, s19, 0
  s_mov_b32 s78, 4194304
  s_mov_b32 s79, 0x20000
  s_lshr_b32 s69, s65, 2
  v_cmp_gt_u32 s[74:75], s69, v0
  s_lshl_b32 s69, s67, 5
  v_lshl_add_u32 v53, v0, 7, s69
  v_add_u32 v55, 32, v53
  v_add_u32 v57, 64, v53
  v_add_u32 v59, 96, v53
  v_lshlrev_b32 v23, 24, v0
  v_and_b32 v23, 0xfc000000, v23
  v_and_b32 v21, 3, v0
  v_lshl_or_b32 v23, v21, 5, v23
  s_lshr_b32 s3, s64, 2
  s_mov_b32 s71, 171196
  v_mov_b32 v22, 8192
  v_mov_b32 v20, 1
  s_waitcnt lgkmcnt(0)
  s_barrier
  s_mov_b64 exec, s[74:75]
  s_waitcnt vmcnt(1)
  v_mad_u32_u24 v16, v8, s71, v22
  v_lshrrev_b32 v16, 20, v16
  v_lshrrev_b32 v28, 2, v16
  v_and_b32 v28, 0x3fc, v28
  ds_add_rtn_u32 v24, v28, v20 offset:0
  v_mad_u32_u24 v17, v9, s71, v22
  v_lshrrev_b32 v17, 20, v17
  v_lshrrev_b32 v29, 2, v17
  v_and_b32 v29, 0x3fc, v29
  ds_add_rtn_u32 v25, v29, v20 offset:0
  v_mad_u32_u24 v18, v10, s71, v22
  v_lshrrev_b32 v18, 20, v18
  v_lshrrev_b32 v30, 2, v18
  v_and_b32 v30, 0x3fc, v30
  ds_add_rtn_u32 v26, v30, v20 offset:0
  v_mad_u32_u24 v19, v11, s71, v22
  v_lshrrev_b32 v19, 20, v19
  v_lshrrev_b32 v31, 2, v19
  v_and_b32 v31, 0x3fc, v31
  ds_add_rtn_u32 v27, v31, v20 offset:0
  v_mad_u32_u24 v21, v16, 49, 7
  v_lshrrev_b32 v21, 3, v21
  v_sub_u32 v8, v8, v21
  v_mad_u32_u24 v21, v17, 49, 7
  v_lshrrev_b32 v21, 3, v21
  v_sub_u32 v9, v9, v21
  v_mad_u32_u24 v21, v18, 49, 7
  v_lshrrev_b32 v21, 3, v21
  v_sub_u32 v10, v10, v21
  v_mad_u32_u24 v21, v19, 49, 7
  v_lshrrev_b32 v21, 3, v21
  v_sub_u32 v11, v11, v21
  v_and_b32 v16, 15, v16
  v_lshl_or_b32 v8, v16, 22, v8
  v_add3_u32 v8, v8, v23, 0
  v_and_b32 v17, 15, v17
  v_lshl_or_b32 v9, v17, 22, v9
  v_add3_u32 v9, v9, v23, 8
  v_and_b32 v18, 15, v18
  v_lshl_or_b32 v10, v18, 22, v10
  v_add3_u32 v10, v10, v23, 16
  v_and_b32 v19, 15, v19
  v_lshl_or_b32 v11, v19, 22, v11
  v_add3_u32 v11, v11, v23, 24
  s_waitcnt vmcnt(0)
  v_lshl_or_b32 v52, v12, 7, v8
  v_lshl_or_b32 v54, v13, 7, v9
  v_lshl_or_b32 v56, v14, 7, v10
  v_lshl_or_b32 v58, v15, 7, v11
  s_waitcnt lgkmcnt(3)
  v_cmp_gt_u32 vcc, 16, v24
  v_lshlrev_b32 v12, 1, v24
  v_lshlrev_b32 v24, 2, v24
  v_mad_u32_u24 v21, v28, 20, v24
  v_lshlrev_b32 v12, v12, s3
  s_andn2_b64 s[80:81], exec, vcc
  s_mov_b64 exec, vcc
  ds_write_b32 v21, v52 offset:23552
  ds_or_b32 v28, v12 offset:1024
  s_mov_b64 exec, s[74:75]
  s_waitcnt lgkmcnt(4)
  v_cmp_gt_u32 vcc, 16, v25
  v_lshlrev_b32 v13, 1, v25
  v_lshlrev_b32 v25, 2, v25
  v_mad_u32_u24 v21, v29, 20, v25
  v_lshlrev_b32 v13, v13, s3
  s_andn2_b64 s[82:83], exec, vcc
  s_mov_b64 exec, vcc
  ds_write_b32 v21, v54 offset:23552
  ds_or_b32 v29, v13 offset:1024
  s_mov_b64 exec, s[74:75]
  s_waitcnt lgkmcnt(5)
  v_cmp_gt_u32 vcc, 16, v26
  v_lshlrev_b32 v14, 1, v26
  v_lshlrev_b32 v26, 2, v26
  v_mad_u32_u24 v21, v30, 20, v26
  v_lshlrev_b32 v14, v14, s3
  s_andn2_b64 s[84:85], exec, vcc
  s_mov_b64 exec, vcc
  ds_write_b32 v21, v56 offset:23552
  ds_or_b32 v30, v14 offset:1024
  s_mov_b64 exec, s[74:75]
  s_waitcnt lgkmcnt(6)
  v_cmp_gt_u32 vcc, 16, v27
  v_lshlrev_b32 v15, 1, v27
  v_lshlrev_b32 v27, 2, v27
  v_mad_u32_u24 v21, v31, 20, v27
  v_lshlrev_b32 v15, v15, s3
  s_andn2_b64 s[86:87], exec, vcc
  s_mov_b64 exec, vcc
  ds_write_b32 v21, v58 offset:23552
  ds_or_b32 v31, v15 offset:1024
  s_mov_b64 exec, -1
  s_mov_b32 s70, 80
  v_lshrrev_b32 v16, 2, v0
  v_and_b32 v19, 0x30, v3
  v_mad_u32_u24 v17, v16, s70, v19
  v_add_u32 v18, s88, v16
  v_and_b32 v18, 15, v18
  v_lshl_add_u32 v18, v16, 4, v18
  v_lshl_add_u32 v18, v18, 4, s89
  v_lshl_add_u32 v18, v18, 6, v19
  v_lshlrev_b32 v4, 4, v2
  s_waitcnt lgkmcnt(0)
  s_barrier
  ds_read_b128 v[60:63], v17 offset:23552
  ds_read_b128 v[8:11], v4 offset:0
  ds_read_b128 v[20:23], v4 offset:1024
  s_waitcnt lgkmcnt(2)
  buffer_store_dwordx4 v[60:63], v18, s[76:79], 0 offen sc1
  s_waitcnt lgkmcnt(0)
  v_subrev_u32 v12, 16, v8
  v_subrev_u32 v13, 16, v9
  v_subrev_u32 v14, 16, v10
  v_subrev_u32 v15, 16, v11
  v_max_i32 v12, 0, v12
  v_max_i32 v13, 0, v13
  v_max_i32 v14, 0, v14
  v_max_i32 v15, 0, v15
  v_add_u32 v13, v12, v13
  v_add_u32 v14, v13, v14
  v_add_u32 v15, v14, v15
  v_mov_b32 v5, v15
  s_nop 1
  v_add_u32_dpp v5, v5, v5 row_shr:1 row_mask:0xf bank_mask:0xf bound_ctrl:1
  s_nop 1
  v_add_u32_dpp v5, v5, v5 row_shr:2 row_mask:0xf bank_mask:0xf bound_ctrl:1
  s_nop 1
  v_add_u32_dpp v5, v5, v5 row_shr:4 row_mask:0xf bank_mask:0xf bound_ctrl:1
  s_nop 1
  v_add_u32_dpp v5, v5, v5 row_shr:8 row_mask:0xf bank_mask:0xf bound_ctrl:1
  s_nop 1
  v_add_u32_dpp v5, v5, v5 row_bcast:15 row_mask:0xa bank_mask:0xf
  s_nop 1
  v_add_u32_dpp v5, v5, v5 row_bcast:31 row_mask:0xc bank_mask:0xf
  v_sub_u32 v16, v5, v15
  v_add_u32 v17, v16, v12
  v_add_u32 v18, v16, v13
  v_add_u32 v19, v16, v14
  ds_write_b128 v4, v[16:19] offset:2048
  s_mov_b64 exec, s[80:81]
  ds_read_b32 v28, v28 offset:2048
  s_mov_b64 exec, s[82:83]
  ds_read_b32 v29, v29 offset:2048
  s_mov_b64 exec, s[84:85]
  ds_read_b32 v30, v30 offset:2048
  s_mov_b64 exec, s[86:87]
  ds_read_b32 v31, v31 offset:2048
  s_mov_b64 exec, -1
  s_cmp_ge_u32 s64, 4
  s_cbranch_scc1 K1_NOTAB
  v_lshl_add_u32 v5, v2, 2, s64
  v_add_u32 v6, s88, v5
  v_and_b32 v6, 15, v6
  v_lshl_add_u32 v5, v5, 4, v6
  v_lshl_add_u32 v5, v5, 4, s89
  v_lshlrev_b32 v5, 3, v5
  s_cmp_lg_u32 s64, 0
  s_cbranch_scc1 K1_TB0
  v_lshl_or_b32 v6, v16, 16, v8
  v_mov_b32 v7, v20
K1_TB0:
  s_cmp_lg_u32 s64, 1
  s_cbranch_scc1 K1_TB1
  v_lshl_or_b32 v6, v17, 16, v9
  v_mov_b32 v7, v21
K1_TB1:
  s_cmp_lg_u32 s64, 2
  s_cbranch_scc1 K1_TB2
  v_lshl_or_b32 v6, v18, 16, v10
  v_mov_b32 v7, v22
K1_TB2:
  s_cmp_lg_u32 s64, 3
  s_cbranch_scc1 K1_TB3
  v_lshl_or_b32 v6, v19, 16, v11
  v_mov_b32 v7, v23
K1_TB3:
  buffer_store_dwordx2 v[6:7], v5, s[44:47], 0 offen
K1_NOTAB:
  s_waitcnt lgkmcnt(0)
  s_mov_b64 exec, s[80:81]
  s_cbranch_execz K1_NOOV0
  v_lshl_add_u32 v28, v28, 2, v24
  v_lshlrev_b32 v28, 1, v28
  buffer_store_dwordx2 v[52:53], v28, s[40:43], 0 offen sc1
K1_NOOV0:
  s_mov_b64 exec, s[82:83]
  s_cbranch_execz K1_NOOV1
  v_lshl_add_u32 v29, v29, 2, v25
  v_lshlrev_b32 v29, 1, v29
  buffer_store_dwordx2 v[54:55], v29, s[40:43], 0 offen sc1
K1_NOOV1:
  s_mov_b64 exec, s[84:85]
  s_cbranch_execz K1_NOOV2
  v_lshl_add_u32 v30, v30, 2, v26
  v_lshlrev_b32 v30, 1, v30
  buffer_store_dwordx2 v[56:57], v30, s[40:43], 0 offen sc1
K1_NOOV2:
  s_mov_b64 exec, s[86:87]
  s_cbranch_execz K1_NOOV3
  v_lshl_add_u32 v31, v31, 2, v27
  v_lshlrev_b32 v31, 1, v31
  buffer_store_dwordx2 v[58:59], v31, s[40:43], 0 offen sc1
K1_NOOV3:
  s_mov_b64 exec, -1
  s_branch K1_FIN
K1_G0:
  s_mov_b32 s36, s12
  s_mov_b32 s37, s13
  s_mov_b32 s38, 18560
  s_mov_b32 s39, 0x20000
  s_lshl_b32 s69, s68, 7
  s_lshl_b32 s70, s66, 7
  s_add_u32 s28, s4, s69
  s_addc_u32 s29, s5, 0
  s_mov_b32 s30, s70
  s_mov_b32 s31, 0x20000
  s_add_u32 s69, s69, 0x680000
  s_add_u32 s48, s18, s69
  s_addc_u32 s49, s19, 0
  s_mov_b32 s50, s70
  s_mov_b32 s51, 0x20000
  s_add_u32 s76, s18, 0xc00000
  s_addc_u32 s77, s19, 0
  s_mov_b32 s78, 4194304
  s_mov_b32 s79, 0x20000
  s_lshl_b32 s69, s68, 4
  s_add_u32 s69, s69, 0xa00000
  s_lshl_b32 s70, s66, 4
  s_add_u32 s52, s18, s69
  s_addc_u32 s53, s19, 0
  s_mov_b32 s54, s70
  s_mov_b32 s55, 0x20000
  s_sub_u32 s69, s64, 13
  s_mul_i32 s69, s69, 3072
  s_add_u32 m0, s69, 3072
  s_add_u32 s69, s69, 8192
  v_lshlrev_b32 v4, 4, v2
  buffer_load_dwordx4 v4, s[36:39], s69 offen offset:0 lds
  buffer_load_dwordx4 v4, s[36:39], s69 offen offset:1024 lds
  buffer_load_dwordx4 v4, s[36:39], s69 offen offset:2048 lds
  s_sub_u32 s69, 15, s64
  s_lshl_b32 s69, s69, 12
  v_and_b32 v5, 31, v2
  v_lshrrev_b32 v6, 5, v2
  v_lshlrev_b32 v7, 7, v5
  v_lshl_add_u32 v7, v6, 4, v7
  v_add_u32 v7, s69, v7
  s_mov_b32 s72, 0xbfb8aa3b
  s_mov_b32 s73, 0xbfb8aa3b
  buffer_load_dwordx4 v[32:35], v7, s[28:31], 0 offen offset:0
  buffer_load_dwordx4 v[36:39], v7, s[28:31], 0 offen offset:32
  buffer_load_dwordx4 v[40:43], v7, s[28:31], 0 offen offset:64
  buffer_load_dwordx4 v[44:47], v7, s[28:31], 0 offen offset:96
  v_subrev_u32 v24, 832, v0
  s_cmp_eq_u32 s64, 15
  s_cbranch_scc1 K1_PREP
  s_mul_i32 s69, s68, 6
  s_mul_i32 s70, s66, 6
  s_add_u32 s32, s6, s69
  s_addc_u32 s33, s7, 0
  s_mov_b32 s34, s70
  s_mov_b32 s35, 0x20000
  v_mul_u32_u24 v25, 6, v24
  buffer_load_ushort v48, v25, s[32:35], 0 offen
  buffer_load_ushort v49, v25, s[32:35], 0 offen offset:2
  buffer_load_ushort v50, v25, s[32:35], 0 offen offset:4
  s_cmp_lg_u32 s64, 13
  s_cbranch_scc1 K1_W7
  v_add_u32 v7, 4096, v7
  buffer_load_dwordx4 v[8:11], v7, s[28:31], 0 offen offset:0
  buffer_load_dwordx4 v[12:15], v7, s[28:31], 0 offen offset:32
  buffer_load_dwordx4 v[16:19], v7, s[28:31], 0 offen offset:64
  buffer_load_dwordx4 v[20:23], v7, s[28:31], 0 offen offset:96
  s_waitcnt vmcnt(11)
  s_branch K1_G2
K1_W7:
  s_waitcnt vmcnt(7)
  s_branch K1_G2
K1_PREP:
  s_cmp_ge_u32 s2, 26
  s_cbranch_scc1 K1_PREP2
  s_cmp_ge_u32 s2, 10
  s_cbranch_scc1 K1_PWH
  s_lshr_b32 s69, s2, 1
  s_lshl_b32 s69, s69, 4
  s_cmp_ge_u32 s2, 8
  s_cselect_b32 s69, 129, s69
  s_and_b32 s70, s2, 1
  s_lshl_b32 s70, s70, 6
  s_lshl_b32 s69, s69, 7
  s_add_u32 s69, s69, s70
  v_lshlrev_b32 v17, 10, v6
  v_lshl_add_u32 v17, v5, 1, v17
  v_add_u32 v17, s69, v17
  s_mov_b32 s56, s12
  s_mov_b32 s57, s13
  s_mov_b32 s58, 18560
  s_branch K1_PLD
K1_PWH:
  s_sub_u32 s69, s2, 10
  s_and_b32 s70, s69, 3
  s_lshr_b32 s69, s69, 2
  s_lshl_b32 s69, s69, 12
  s_lshl_b32 s70, s70, 1
  s_add_u32 s69, s69, s70
  v_lshrrev_b32 v17, 4, v2
  v_lshlrev_b32 v17, 10, v17
  v_and_b32 v18, 15, v2
  v_lshl_add_u32 v17, v18, 3, v17
  v_add_u32 v17, s69, v17
  s_mov_b32 s56, s16
  s_mov_b32 s57, s17
  s_mov_b32 s58, 16384
K1_PLD:
  s_mov_b32 s59, 0x20000
  buffer_load_ushort v48, v17, s[56:59], 0 offen offset:0
  buffer_load_ushort v49, v17, s[56:59], 0 offen offset:128
  buffer_load_ushort v50, v17, s[56:59], 0 offen offset:256
  buffer_load_ushort v51, v17, s[56:59], 0 offen offset:384
  buffer_load_ushort v52, v17, s[56:59], 0 offen offset:512
  buffer_load_ushort v53, v17, s[56:59], 0 offen offset:640
  buffer_load_ushort v54, v17, s[56:59], 0 offen offset:768
  buffer_load_ushort v55, v17, s[56:59], 0 offen offset:896
  s_waitcnt vmcnt(12)
  s_branch K1_G2
K1_PREP2:
  s_cmp_lg_u32 s2, 26
  s_cbranch_scc1 K1_W4
  s_mov_b32 s56, s14
  s_mov_b32 s57, s15
  s_mov_b32 s58, 128
  s_mov_b32 s59, 0x20000
  v_lshlrev_b32 v17, 1, v2
  v_add_u32 v17, 16384, v17
  buffer_load_ushort v48, v17, s[36:39], 0 offen
  v_and_b32 v18, 3, v2
  v_bfe_u32 v19, v2, 2, 2
  v_lshl_add_u32 v18, v19, 3, v18
  v_lshl_add_u32 v18, v6, 2, v18
  v_bfe_u32 v19, v2, 4, 1
  v_lshl_add_u32 v18, v19, 5, v18
  v_lshlrev_b32 v18, 1, v18
  buffer_load_ushort v49, v18, s[56:59], 0 offen
K1_W4:
  s_waitcnt vmcnt(4)
K1_G2:
  v_bfe_u32 v26, v2, 2, 2
  v_lshl_add_u32 v26, v6, 3, v26
  v_lshlrev_b32 v26, 7, v26
  v_and_b32 v27, 1, v2
  v_lshl_add_u32 v26, v27, 5, v26
  v_bfe_u32 v27, v2, 4, 1
  v_lshl_add_u32 v26, v27, 4, v26
  v_bfe_u32 v27, v2, 1, 1
  v_lshl_add_u32 v26, v27, 3, v26
  s_sub_u32 s69, s64, 13
  s_lshl_b32 s69, s69, 12
  v_lshl_add_u32 v28, v5, 7, s69
  v_and_b32 v27, 7, v5
  v_lshlrev_b32 v29, 1, v6
  v_xor_b32 v29, v29, v27
  v_lshl_add_u32 v28, v29, 4, v28
  v_lshl_add_u32 v30, v2, 4, s69
  v_lshrrev_b32 v31, 3, v2
  v_lshlrev_b32 v31, 4, v31
  v_lshlrev_b32 v27, 4, v2
  v_xor_b32 v31, v31, v27
  s_mov_b32 s70, 80
  s_barrier
  ds_read_b64_tr_b16 v[64:65], v26 offset:3072
  ds_read_b64_tr_b16 v[66:67], v26 offset:3584
  ds_read_b64_tr_b16 v[68:69], v26 offset:5120
  ds_read_b64_tr_b16 v[70:71], v26 offset:5632
  ds_read_b64_tr_b16 v[72:73], v26 offset:7168
  ds_read_b64_tr_b16 v[74:75], v26 offset:7680
  ds_read_b64_tr_b16 v[76:77], v26 offset:9216
  ds_read_b64_tr_b16 v[78:79], v26 offset:9728
  ds_read_b64_tr_b16 v[80:81], v26 offset:3136
  ds_read_b64_tr_b16 v[82:83], v26 offset:3648
  ds_read_b64_tr_b16 v[84:85], v26 offset:5184
  ds_read_b64_tr_b16 v[86:87], v26 offset:5696
  ds_read_b64_tr_b16 v[88:89], v26 offset:7232
  ds_read_b64_tr_b16 v[90:91], v26 offset:7744
  ds_read_b64_tr_b16 v[92:93], v26 offset:9280
  ds_read_b64_tr_b16 v[94:95], v26 offset:9792
  s_waitcnt lgkmcnt(8) vmcnt(0)
  v_mfma_f32_32x32x16_bf16 v[96:111], v[64:67], v[32:35], 0
  v_mfma_f32_32x32x16_bf16 v[96:111], v[68:71], v[36:39], v[96:111]
  v_mfma_f32_32x32x16_bf16 v[96:111], v[72:75], v[40:43], v[96:111]
  v_mfma_f32_32x32x16_bf16 v[96:111], v[76:79], v[44:47], v[96:111]
  s_waitcnt lgkmcnt(0)
  v_mfma_f32_32x32x16_bf16 v[112:127], v[80:83], v[32:35], 0
  v_mfma_f32_32x32x16_bf16 v[112:127], v[84:87], v[36:39], v[112:127]
  v_mfma_f32_32x32x16_bf16 v[112:127], v[88:91], v[40:43], v[112:127]
  v_mfma_f32_32x32x16_bf16 v[112:127], v[92:95], v[44:47], v[112:127]
  s_cmp_eq_u32 s64, 15
  s_cbranch_scc1 K1_SIDE_PREP
  v_lshlrev_b32 v24, 4, v24
  v_lshlrev_b32 v48, 16, v48
  v_lshlrev_b32 v49, 16, v49
  v_lshlrev_b32 v50, 16, v50
  v_mov_b32 v51, 0
  buffer_store_dwordx4 v[48:51], v24, s[52:55], 0 offen sc1
  s_branch K1_SIDE_DONE
K1_SIDE_PREP:
  s_cmp_gt_u32 s2, 26
  s_cbranch_scc1 K1_SIDE_DONE
  s_add_u32 s60, s18, 0xa80000
  s_addc_u32 s61, s19, 0
  s_mov_b32 s62, 27136
  s_mov_b32 s63, 0x20000
  s_cmp_eq_u32 s2, 26
  s_cbranch_scc1 K1_SIDE_WD
  s_lshr_b32 s69, s2, 1
  s_cmp_eq_u32 s69, 4
  s_cbranch_scc1 K1_SIDE_W3
  v_lshl_or_b32 v56, v49, 16, v48
  v_lshl_or_b32 v57, v51, 16, v50
  v_lshl_or_b32 v58, v53, 16, v52
  v_lshl_or_b32 v59, v55, 16, v54
  s_branch K1_SIDE_ST
K1_SIDE_W3:
  v_lshlrev_b32 v48, 16, v48
  v_mul_f32 v48, s72, v48
  v_lshlrev_b32 v49, 16, v49
  v_mul_f32 v49, s72, v49
  v_lshlrev_b32 v50, 16, v50
  v_mul_f32 v50, s72, v50
  v_lshlrev_b32 v51, 16, v51
  v_mul_f32 v51, s72, v51
  v_lshlrev_b32 v52, 16, v52
  v_mul_f32 v52, s72, v52
  v_lshlrev_b32 v53, 16, v53
  v_mul_f32 v53, s72, v53
  v_lshlrev_b32 v54, 16, v54
  v_mul_f32 v54, s72, v54
  v_lshlrev_b32 v55, 16, v55
  v_mul_f32 v55, s72, v55
  v_cvt_pk_bf16_f32 v56, v48, v49
  v_cvt_pk_bf16_f32 v57, v50, v51
  v_cvt_pk_bf16_f32 v58, v52, v53
  v_cvt_pk_bf16_f32 v59, v54, v55
K1_SIDE_ST:
  s_lshl_b32 s69, s2, 10
  v_lshl_add_u32 v16, v2, 4, s69
  buffer_store_dwordx4 v[56:59], v16, s[60:63], 0 offen sc1
  s_branch K1_SIDE_DONE
K1_SIDE_WD:
  v_lshlrev_b32 v48, 16, v48
  v_mul_f32 v48, s72, v48
  v_cvt_pk_bf16_f32 v50, v48, v48
  v_and_b32 v51, 0xffff0000, v50
  v_sub_f32 v51, v48, v51
  v_cvt_pk_bf16_f32 v50, v48, v51
  v_lshlrev_b32 v49, 16, v49
  v_mul_f32 v49, 0xbf317218, v49
  v_lshlrev_b32 v16, 2, v2
  v_add_u32 v16, 26624, v16
  buffer_store_dword v50, v16, s[60:63], 0 offen sc1
  buffer_store_dword v49, v16, s[60:63], 0 offen offset:256 sc1
K1_SIDE_DONE:
  s_sub_u32 s69, 15, s64
  s_lshl_b32 s69, s69, 12
  s_nop 0
  v_pk_mul_f32 v[96:97], v[96:97], s[72:73]
  v_pk_mul_f32 v[98:99], v[98:99], s[72:73]
  v_pk_mul_f32 v[100:101], v[100:101], s[72:73]
  v_pk_mul_f32 v[102:103], v[102:103], s[72:73]
  v_pk_mul_f32 v[104:105], v[104:105], s[72:73]
  v_pk_mul_f32 v[106:107], v[106:107], s[72:73]
  v_pk_mul_f32 v[108:109], v[108:109], s[72:73]
  v_pk_mul_f32 v[110:111], v[110:111], s[72:73]
  v_cvt_pk_bf16_f32 v96, v96, v97
  v_cvt_pk_bf16_f32 v97, v98, v99
  v_cvt_pk_bf16_f32 v98, v100, v101
  v_cvt_pk_bf16_f32 v99, v102, v103
  v_cvt_pk_bf16_f32 v100, v104, v105
  v_cvt_pk_bf16_f32 v101, v106, v107
  v_cvt_pk_bf16_f32 v102, v108, v109
  v_cvt_pk_bf16_f32 v103, v110, v111
  ds_write_b128 v28, v[96:99] offset:11264
  v_xor_b32 v29, 16, v28
  ds_write_b128 v29, v[100:103] offset:11264
  v_pk_mul_f32 v[112:113], v[112:113], s[72:73]
  v_pk_mul_f32 v[114:115], v[114:115], s[72:73]
  v_pk_mul_f32 v[116:117], v[116:117], s[72:73]
  v_pk_mul_f32 v[118:119], v[118:119], s[72:73]
  v_pk_mul_f32 v[120:121], v[120:121], s[72:73]
  v_pk_mul_f32 v[122:123], v[122:123], s[72:73]
  v_pk_mul_f32 v[124:125], v[124:125], s[72:73]
  v_pk_mul_f32 v[126:127], v[126:127], s[72:73]
  v_cvt_pk_bf16_f32 v112, v112, v113
  v_cvt_pk_bf16_f32 v113, v114, v115
  v_cvt_pk_bf16_f32 v114, v116, v117
  v_cvt_pk_bf16_f32 v115, v118, v119
  v_cvt_pk_bf16_f32 v116, v120, v121
  v_cvt_pk_bf16_f32 v117, v122, v123
  v_cvt_pk_bf16_f32 v118, v124, v125
  v_cvt_pk_bf16_f32 v119, v126, v127
  v_xor_b32 v29, 64, v28
  ds_write_b128 v29, v[112:115] offset:11264
  v_xor_b32 v29, 80, v28
  ds_write_b128 v29, v[116:119] offset:11264
  ds_read_b128 v[96:99], v30 offset:11264
  ds_read_b128 v[100:103], v30 offset:12288
  ds_read_b128 v[104:107], v30 offset:13312
  ds_read_b128 v[108:111], v30 offset:14336
  v_add_u32 v27, s69, v31
  s_waitcnt lgkmcnt(3)
  buffer_store_dwordx4 v[96:99], v27, s[48:51], 0 offen offset:0 sc1
  s_waitcnt lgkmcnt(2)
  buffer_store_dwordx4 v[100:103], v27, s[48:51], 0 offen offset:1024 sc1
  s_waitcnt lgkmcnt(1)
  buffer_store_dwordx4 v[104:107], v27, s[48:51], 0 offen offset:2048 sc1
  s_waitcnt lgkmcnt(0)
  buffer_store_dwordx4 v[108:111], v27, s[48:51], 0 offen offset:3072 sc1
  s_cmp_lg_u32 s64, 13
  s_cbranch_scc1 K1_G3
  v_mfma_f32_32x32x16_bf16 v[96:111], v[64:67], v[8:11], 0
  v_mfma_f32_32x32x16_bf16 v[96:111], v[68:71], v[12:15], v[96:111]
  v_mfma_f32_32x32x16_bf16 v[96:111], v[72:75], v[16:19], v[96:111]
  v_mfma_f32_32x32x16_bf16 v[96:111], v[76:79], v[20:23], v[96:111]
  v_mfma_f32_32x32x16_bf16 v[112:127], v[80:83], v[8:11], 0
  v_mfma_f32_32x32x16_bf16 v[112:127], v[84:87], v[12:15], v[112:127]
  v_mfma_f32_32x32x16_bf16 v[112:127], v[88:91], v[16:19], v[112:127]
  v_mfma_f32_32x32x16_bf16 v[112:127], v[92:95], v[20:23], v[112:127]
K1_G3:
  s_mov_b32 s70, 80
  v_lshrrev_b32 v56, 2, v0
  v_and_b32 v59, 0x30, v3
  v_mad_u32_u24 v57, v56, s70, v59
  v_add_u32 v58, s88, v56
  v_and_b32 v58, 15, v58
  v_lshl_add_u32 v58, v56, 4, v58
  v_lshl_add_u32 v58, v58, 4, s89
  v_lshl_add_u32 v58, v58, 6, v59
  s_barrier
  ds_read_b128 v[60:63], v57 offset:23552
  s_waitcnt lgkmcnt(0)
  buffer_store_dwordx4 v[60:63], v58, s[76:79], 0 offen sc1
  s_cmp_lg_u32 s64, 13
  s_cbranch_scc1 K1_FIN
  s_mov_b32 s69, 12288
  v_pk_mul_f32 v[96:97], v[96:97], s[72:73]
  v_pk_mul_f32 v[98:99], v[98:99], s[72:73]
  v_pk_mul_f32 v[100:101], v[100:101], s[72:73]
  v_pk_mul_f32 v[102:103], v[102:103], s[72:73]
  v_pk_mul_f32 v[104:105], v[104:105], s[72:73]
  v_pk_mul_f32 v[106:107], v[106:107], s[72:73]
  v_pk_mul_f32 v[108:109], v[108:109], s[72:73]
  v_pk_mul_f32 v[110:111], v[110:111], s[72:73]
  v_cvt_pk_bf16_f32 v96, v96, v97
  v_cvt_pk_bf16_f32 v97, v98, v99
  v_cvt_pk_bf16_f32 v98, v100, v101
  v_cvt_pk_bf16_f32 v99, v102, v103
  v_cvt_pk_bf16_f32 v100, v104, v105
  v_cvt_pk_bf16_f32 v101, v106, v107
  v_cvt_pk_bf16_f32 v102, v108, v109
  v_cvt_pk_bf16_f32 v103, v110, v111
  ds_write_b128 v28, v[96:99] offset:11264
  v_xor_b32 v29, 16, v28
  ds_write_b128 v29, v[100:103] offset:11264
  v_pk_mul_f32 v[112:113], v[112:113], s[72:73]
  v_pk_mul_f32 v[114:115], v[114:115], s[72:73]
  v_pk_mul_f32 v[116:117], v[116:117], s[72:73]
  v_pk_mul_f32 v[118:119], v[118:119], s[72:73]
  v_pk_mul_f32 v[120:121], v[120:121], s[72:73]
  v_pk_mul_f32 v[122:123], v[122:123], s[72:73]
  v_pk_mul_f32 v[124:125], v[124:125], s[72:73]
  v_pk_mul_f32 v[126:127], v[126:127], s[72:73]
  v_cvt_pk_bf16_f32 v112, v112, v113
  v_cvt_pk_bf16_f32 v113, v114, v115
  v_cvt_pk_bf16_f32 v114, v116, v117
  v_cvt_pk_bf16_f32 v115, v118, v119
  v_cvt_pk_bf16_f32 v116, v120, v121
  v_cvt_pk_bf16_f32 v117, v122, v123
  v_cvt_pk_bf16_f32 v118, v124, v125
  v_cvt_pk_bf16_f32 v119, v126, v127
  v_xor_b32 v29, 64, v28
  ds_write_b128 v29, v[112:115] offset:11264
  v_xor_b32 v29, 80, v28
  ds_write_b128 v29, v[116:119] offset:11264
  ds_read_b128 v[96:99], v30 offset:11264
  ds_read_b128 v[100:103], v30 offset:12288
  ds_read_b128 v[104:107], v30 offset:13312
  ds_read_b128 v[108:111], v30 offset:14336
  v_add_u32 v27, s69, v31
  s_waitcnt lgkmcnt(3)
  buffer_store_dwordx4 v[96:99], v27, s[48:51], 0 offen offset:0 sc1
  s_waitcnt lgkmcnt(2)
  buffer_store_dwordx4 v[100:103], v27, s[48:51], 0 offen offset:1024 sc1
  s_waitcnt lgkmcnt(1)
  buffer_store_dwordx4 v[104:107], v27, s[48:51], 0 offen offset:2048 sc1
  s_waitcnt lgkmcnt(0)
  buffer_store_dwordx4 v[108:111], v27, s[48:51], 0 offen offset:3072 sc1
K1_FIN:
K1_END:
  s_endpgm
.globl egnn_main_kernel
.p2align 8
.type egnn_main_kernel,@function
egnn_main_kernel:
  s_cmp_ge_u32 s2, 256
  s_cbranch_scc1 K2_END
  s_load_dwordx2 s[10:11], s[0:1], 80
  s_load_dwordx2 s[4:5], s[0:1], 0
  s_load_dwordx2 s[6:7], s[0:1], 16
  s_load_dwordx2 s[8:9], s[0:1], 64
  v_mov_b32 v127, v0
  v_lshrrev_b32 v1, 6, v0
  v_and_b32 v2, 0x3fc, v0
  v_lshlrev_b32 v2, 1, v2
  v_readfirstlane_b32 s48, v1
  s_lshl_b32 s56, s2, 11
  s_add_u32 s56, s56, 0x1400000
  s_mov_b32 s51, 0
  s_mov_b32 s52, 0
  s_mov_b32 s53, 16
  s_mov_b32 s69, 1
  s_waitcnt lgkmcnt(0)
  s_add_u32 s12, s10, s56
  s_addc_u32 s13, s11, 0
  s_mov_b32 s14, 2048
  s_mov_b32 s15, 0x20000
  buffer_load_dwordx2 v[88:89], v2, s[12:15], 0 offen
  s_lshl_b32 s56, s2, 14
  s_add_u32 s56, s56, 0xc00000
  s_add_u32 s92, s10, s56
  s_addc_u32 s93, s11, 0
  s_mov_b32 s94, 16384
  s_mov_b32 s95, 0x20000
  v_lshlrev_b32 v16, 2, v0
  v_lshlrev_b32 v91, 4, v127
  buffer_load_dwordx4 v[0:3], v91, s[92:95], 0 offen
  v_and_b32 v93, 3, v127
  v_lshrrev_b32 v90, 2, v127
  s_add_u32 s16, s10, 0x3ff80
  s_addc_u32 s17, s11, 0
  s_mov_b32 s18, 6406272
  s_mov_b32 s19, 0x20000
  v_lshrrev_b32 v91, 4, v90
  v_subrev_u32 v91, s2, v91
  v_and_b32 v90, 15, v90
  v_bfe_u32 v94, v91, 1, 3
  v_lshl_add_u32 v90, v90, 3, v94
  v_and_b32 v91, 1, v91
  v_lshl_add_u32 v90, v91, 7, v90
  s_lshl_b32 s56, s51, 5
  v_lshl_add_u32 v91, v93, 1, s56
  v_mul_u32_u24 v94, 3128, v90
  v_add_u32 v90, v94, v91
  v_lshlrev_b32 v93, 2, v93
  s_cmp_ge_u32 s48, s52
  s_cselect_b32 s56, -1, 0
  s_cmp_lt_u32 s48, s53
  s_cselect_b32 s56, s56, 0
  v_mov_b32 v17, 0
  s_mov_b32 s59, s56
  s_cmp_gt_u32 s48, 8
  s_cbranch_scc1 K2_NOZ
  ds_write_b32 v16, v17 offset:0
K2_NOZ:
  s_mov_b32 s64, 0
  s_mov_b32 s65, -1
  s_mov_b32 s66, 1.0
  s_mov_b32 s67, 1.0
  s_mov_b32 s68, 0x3fff80
  s_mov_b32 s72, 0x88888888
  s_mov_b32 s73, 0x88888888
  s_mul_i32 s60, s48, 4352
  s_add_u32 s60, s60, 69376
  s_add_u32 s61, s60, 1088
  s_add_u32 s62, s60, 2176
  s_add_u32 s63, s60, 3264
  s_add_u32 s28, s10, 0xa00000
  s_addc_u32 s29, s11, 0
  s_mov_b32 s30, 400000
  s_mov_b32 s31, 0x20000
  s_add_u32 s36, s10, 0xa80000
  s_addc_u32 s37, s11, 0
  s_mov_b32 s38, 27136
  s_mov_b32 s39, 0x20000
  s_add_u32 s20, s10, 0x680000
  s_addc_u32 s21, s11, 0
  s_mov_b32 s22, 3200000
  s_mov_b32 s23, 0x20000
  s_mov_b32 s24, s6
  s_mov_b32 s25, s7
  s_mov_b32 s26, 25600000
  s_mov_b32 s27, 0x20000
  s_mov_b32 s32, s4
  s_mov_b32 s33, s5
  s_mov_b32 s34, 0
  s_mov_b32 s35, 0x20000
  s_mov_b32 s40, s8
  s_mov_b32 s41, s9
  s_mov_b32 s42, 0
  s_mov_b32 s43, 0x20000
  s_mov_b32 s44, s8
  s_mov_b32 s45, s9
  s_mov_b32 s46, 0
  s_mov_b32 s47, 0x20000
  v_and_b32 v18, 63, v127
  v_and_b32 v116, 7, v18
  v_lshlrev_b32 v116, 4, v116
  v_lshrrev_b32 v121, 5, v18
  v_lshlrev_b32 v121, 4, v121
  s_cmp_lg_u32 s48, 13
  s_cbranch_scc1 K2_NOOH
  v_bfe_u32 v19, v18, 2, 1
  v_lshlrev_b32 v19, 4, v19
  v_mov_b32 v20, 0x3f80
  v_lshlrev_b32 v19, v19, v20
  v_bfe_u32 v20, v18, 3, 2
  v_and_b32 v21, 3, v18
  v_cmp_eq_u32 vcc, v20, v21
  v_mov_b32 v20, 0xbf317218
  v_lshlrev_b32 v21, 2, v18
  v_cndmask_b32 v19, 0, v19, vcc
  s_mov_b32 exec_hi, 0
  ds_write_b32 v21, v19 offset:2944
  ds_write_b32 v21, v20 offset:2816
  s_mov_b64 exec, -1
K2_NOOH:
  v_lshlrev_b32 v19, 4, v127
  v_lshlrev_b32 v18, 4, v18
  s_mov_b32 s56, s59
  s_waitcnt lgkmcnt(0)
  s_barrier
  s_waitcnt vmcnt(1)
  v_and_b32 v92, 0xffff, v88
  v_lshrrev_b32 v88, 16, v88
  v_sub_u32 v91, v92, v91
  v_add_lshl_u32 v88, v88, v90, 3
  v_and_b32 v91, s56, v91
  v_cmp_lt_i32 s[84:85], 16, v91
  v_cmp_lt_i32 s[86:87], 17, v91
  v_cmp_lt_i32 s[88:89], 24, v91
  v_cmp_lt_i32 s[90:91], 25, v91
  s_mov_b64 exec, s[84:85]
  s_cbranch_execz K2_OV1
  buffer_load_dwordx4 v[8:11], v88, s[16:19], 0 offen offset:128
  s_mov_b64 exec, s[88:89]
  s_cbranch_execz K2_OV1
  buffer_load_dwordx4 v[12:15], v88, s[16:19], 0 offen offset:192
K2_OV1:
  s_mov_b64 exec, -1
  v_sub_u32 v91, v92, v93
  v_and_b32 v91, s56, v91
  v_lshlrev_b32 v93, 1, v93
  v_lshrrev_b32 v89, v93, v89
  v_cmp_lt_i32 s[76:77], 0, v91
  v_cmp_lt_i32 s[78:79], 1, v91
  v_cmp_lt_i32 s[80:81], 2, v91
  v_cmp_lt_i32 s[82:83], 3, v91
  s_lshl_b32 s56, s48, 10
  s_add_u32 m0, s56, 139008
  s_mov_b32 s57, 10240
  buffer_load_dwordx4 v19, s[36:39], s57 offen lds
  s_cmp_ge_u32 s48, 10
  s_cbranch_scc1 K2_DM1
  s_add_u32 s57, s56, 155392
  s_add_u32 s58, s56, -3328
  s_cmp_ge_u32 s48, 8
  s_cselect_b32 m0, s58, s57
  s_nop 0
  buffer_load_dwordx4 v19, s[36:39], 0 offen lds
  s_waitcnt vmcnt(2)
  s_branch K2_HAVE
K2_DM1:
  s_cmp_ge_u32 s48, 12
  s_cbranch_scc1 K2_DM2
  s_sub_u32 s56, s56, 10240
  s_add_u32 m0, s56, 3072
  s_mul_i32 s57, s2, 1568
  s_add_u32 s57, s57, s56
  v_add_u32 v18, s57, v18
  s_cmp_eq_u32 s48, 11
  s_cselect_b32 exec_hi, 0xff, -1
  buffer_load_dwordx4 v18, s[28:31], 0 offen lds
  s_mov_b64 exec, -1
  s_waitcnt vmcnt(2)
  s_branch K2_HAVE
K2_DM2:
  s_cmp_lg_u32 s48, 12
  s_cbranch_scc1 K2_DM3
  s_mov_b32 m0, 2304
  s_mov_b32 s57, 26624
  s_mov_b32 exec_hi, 0
  buffer_load_dwordx4 v18, s[36:39], s57 offen lds
  s_mov_b64 exec, -1
  s_waitcnt vmcnt(2)
  s_branch K2_HAVE
K2_DM3:
  s_waitcnt vmcnt(1)
  s_branch K2_HAVE
K2_ROUND:
  s_waitcnt vmcnt(0)
  s_barrier
  v_mbcnt_lo_u32_b32 v2, -1, 0
  v_mbcnt_hi_u32_b32 v2, -1, v2
  s_lshl_b32 s56, s48, 6
  v_add_u32 v127, s56, v2
  v_and_b32 v2, 0x3fc, v127
  v_lshlrev_b32 v2, 1, v2
  buffer_load_dwordx2 v[88:89], v2, s[12:15], 0 offen
  v_mov_b32 v17, 0
  v_lshlrev_b32 v16, 2, v127
  s_cmp_ge_u32 s48, 4
  s_cbranch_scc1 K2_NOZ2
  ds_write_b32 v16, v17 offset:0
K2_NOZ2:
  v_lshlrev_b32 v91, 4, v127
  buffer_load_dwordx4 v[0:3], v91, s[92:95], 0 offen
  v_and_b32 v93, 3, v127
  v_lshrrev_b32 v90, 2, v127
  v_lshrrev_b32 v91, 4, v90
  v_subrev_u32 v91, s2, v91
  v_and_b32 v90, 15, v90
  v_bfe_u32 v94, v91, 1, 3
  v_lshl_add_u32 v90, v90, 3, v94
  v_and_b32 v91, 1, v91
  v_lshl_add_u32 v90, v91, 7, v90
  s_lshl_b32 s56, s51, 5
  v_lshl_add_u32 v91, v93, 1, s56
  v_mul_u32_u24 v94, 3128, v90
  v_add_u32 v90, v94, v91
  v_lshlrev_b32 v93, 2, v93
  s_cmp_ge_u32 s48, s52
  s_cselect_b32 s56, -1, 0
  s_cmp_lt_u32 s48, s53
  s_cselect_b32 s56, s56, 0
  s_waitcnt vmcnt(0)
  s_cmp_eq_u32 s51, 0
  s_cbranch_scc0 K2_DEEP
  v_and_b32 v92, 0xffff, v88
  v_lshrrev_b32 v88, 16, v88
  v_sub_u32 v91, v92, v91
  v_add_lshl_u32 v88, v88, v90, 3
  v_and_b32 v91, s56, v91
  v_cmp_lt_i32 s[84:85], 16, v91
  v_cmp_lt_i32 s[86:87], 17, v91
  v_cmp_lt_i32 s[88:89], 24, v91
  v_cmp_lt_i32 s[90:91], 25, v91
  s_mov_b64 exec, s[84:85]
  s_cbranch_execz K2_OV2
  buffer_load_dwordx4 v[8:11], v88, s[16:19], 0 offen offset:128
  s_mov_b64 exec, s[88:89]
  s_cbranch_execz K2_OV2
  buffer_load_dwordx4 v[12:15], v88, s[16:19], 0 offen offset:192
K2_OV2:
  s_mov_b64 exec, -1
  v_sub_u32 v91, v92, v93
  v_and_b32 v91, s56, v91
  v_lshlrev_b32 v93, 1, v93
  v_lshrrev_b32 v89, v93, v89
  v_cmp_lt_i32 s[76:77], 0, v91
  v_cmp_lt_i32 s[78:79], 1, v91
  v_cmp_lt_i32 s[80:81], 2, v91
  v_cmp_lt_i32 s[82:83], 3, v91
  s_waitcnt lgkmcnt(0)
  s_barrier
  s_waitcnt vmcnt(0)
  s_branch K2_HAVE
K2_DEEP:
  v_and_b32 v92, 0xffff, v88
  v_lshrrev_b32 v88, 16, v88
  v_sub_u32 v91, v92, v91
  v_add_lshl_u32 v88, v88, v90, 3
  v_and_b32 v91, s56, v91
  v_cmp_lt_i32 s[84:85], 16, v91
  v_cmp_lt_i32 s[86:87], 17, v91
  v_cmp_lt_i32 s[88:89], 24, v91
  v_cmp_lt_i32 s[90:91], 25, v91
  v_cmp_lt_i32 s[76:77], 0, v91
  v_cmp_lt_i32 s[78:79], 1, v91
  v_cmp_lt_i32 s[80:81], 8, v91
  v_cmp_lt_i32 s[82:83], 9, v91
  s_mov_b64 exec, s[76:77]
  buffer_load_dwordx4 v[16:19], v88, s[16:19], 0 offen offset:0
  s_mov_b64 exec, s[80:81]
  buffer_load_dwordx4 v[20:23], v88, s[16:19], 0 offen offset:64
  s_mov_b64 exec, s[84:85]
  s_cbranch_execz K2_OV3
  buffer_load_dwordx4 v[8:11], v88, s[16:19], 0 offen offset:128
  s_mov_b64 exec, s[88:89]
  s_cbranch_execz K2_OV3
  buffer_load_dwordx4 v[12:15], v88, s[16:19], 0 offen offset:192
K2_OV3:
  s_mov_b64 exec, -1
  s_waitcnt lgkmcnt(0)
  s_barrier
  s_waitcnt vmcnt(0)
  v_mov_b32 v0, v16
  v_mov_b32 v4, v17
  v_mov_b32 v1, v18
  v_mov_b32 v5, v19
  v_mov_b32 v2, v20
  v_mov_b32 v6, v21
  v_mov_b32 v3, v22
  v_mov_b32 v7, v23
K2_HAVE:
  v_cmp_lt_u32 vcc, 32, v92
  v_mov_b32 v93, 2048
  v_mov_b32 v95, 1
  s_mov_b64 exec, vcc
  s_cbranch_execz K2_NOMAX
  ds_max_u32 v93, v92
K2_NOMAX:
  s_mov_b64 exec, s[76:77]
  s_cbranch_execz K2_ATOM_MID
  v_lshrrev_b32 v16, 16, v0
  v_and_b32 v16, 0x3fc, v16
  ds_add_rtn_u32 v24, v16, v95 offset:0
  s_mov_b64 exec, s[78:79]
  s_cbranch_execz K2_ATOM_MID
  v_lshrrev_b32 v17, 16, v1
  v_and_b32 v17, 0x3fc, v17
  ds_add_rtn_u32 v25, v17, v95 offset:0
  s_mov_b64 exec, s[80:81]
  s_cbranch_execz K2_ATOM_MID
  v_lshrrev_b32 v18, 16, v2
  v_and_b32 v18, 0x3fc, v18
  ds_add_rtn_u32 v26, v18, v95 offset:0
  s_mov_b64 exec, s[82:83]
  s_cbranch_execz K2_ATOM_MID
  v_lshrrev_b32 v19, 16, v3
  v_and_b32 v19, 0x3fc, v19
  ds_add_rtn_u32 v27, v19, v95 offset:0
K2_ATOM_MID:
  s_mov_b64 exec, s[84:85]
  s_cbranch_execz K2_ATOM_DONE
  v_lshrrev_b32 v20, 16, v8
  v_and_b32 v20, 0x3fc, v20
  ds_add_rtn_u32 v28, v20, v95 offset:0
  s_mov_b64 exec, s[86:87]
  s_cbranch_execz K2_ATOM_DONE
  v_lshrrev_b32 v21, 16, v10
  v_and_b32 v21, 0x3fc, v21
  ds_add_rtn_u32 v29, v21, v95 offset:0
  s_mov_b64 exec, s[88:89]
  s_cbranch_execz K2_ATOM_DONE
  v_lshrrev_b32 v22, 16, v12
  v_and_b32 v22, 0x3fc, v22
  ds_add_rtn_u32 v30, v22, v95 offset:0
  s_mov_b64 exec, s[90:91]
  s_cbranch_execz K2_ATOM_DONE
  v_lshrrev_b32 v23, 16, v14
  v_and_b32 v23, 0x3fc, v23
  ds_add_rtn_u32 v31, v23, v95 offset:0
K2_ATOM_DONE:
  s_mov_b64 exec, -1
  s_cmp_lg_u32 s51, 0
  s_cbranch_scc1 K2_NOW1R
  v_lshrrev_b32 v4, 26, v0
  v_bfe_u32 v90, v0, 3, 4
  v_lshl_or_b32 v4, v4, 4, v90
  v_bfe_u32 v90, v89, 0, 2
  v_lshl_or_b32 v4, v90, 10, v4
  v_add_lshl_u32 v4, v4, v94, 5
  v_lshrrev_b32 v5, 26, v1
  v_bfe_u32 v90, v1, 3, 4
  v_lshl_or_b32 v5, v5, 4, v90
  v_bfe_u32 v90, v89, 2, 2
  v_lshl_or_b32 v5, v90, 10, v5
  v_add_lshl_u32 v5, v5, v94, 5
  v_lshrrev_b32 v6, 26, v2
  v_bfe_u32 v90, v2, 3, 4
  v_lshl_or_b32 v6, v6, 4, v90
  v_bfe_u32 v90, v89, 4, 2
  v_lshl_or_b32 v6, v90, 10, v6
  v_add_lshl_u32 v6, v6, v94, 5
  v_lshrrev_b32 v7, 26, v3
  v_bfe_u32 v90, v3, 3, 4
  v_lshl_or_b32 v7, v7, 4, v90
  v_bfe_u32 v90, v89, 6, 2
  v_lshl_or_b32 v7, v90, 10, v7
  v_add_lshl_u32 v7, v7, v94, 5
K2_NOW1R:
  v_and_b32 v100, 63, v127
  v_lshlrev_b32 v101, 4, v100
  s_cmp_lg_u32 s69, 1
  s_cbranch_scc1 K2_NOVPF
  s_lshr_b32 s56, s2, 3
  s_lshl_b32 s56, s56, 4
  s_add_u32 s56, s56, s48
  s_lshl_b32 s56, s56, 9
  v_and_b32 v95, 3, v100
  v_lshrrev_b32 v96, 2, v100
  v_lshlrev_b32 v96, 18, v96
  v_lshl_add_u32 v95, v95, 7, v96
  v_add_u32 v95, s56, v95
  s_mov_b32 exec_hi, 0x0
  s_mov_b32 exec_lo, 0xffff
  buffer_load_dword v84, v95, s[20:23], 0 offen
  s_mov_b64 exec, -1
K2_NOVPF:
  s_waitcnt lgkmcnt(0)
  s_barrier
  ds_read_b128 v[88:91], v101 offset:0
  ds_read_b32 v102, v93
  s_waitcnt lgkmcnt(0)
  v_readfirstlane_b32 s54, v102
  v_add_u32 v89, v88, v89
  v_add_u32 v90, v89, v90
  v_add_u32 v91, v90, v91
  s_nop 1
  v_add_u32_dpp v92, v91, v91 quad_perm:[1,0,3,2] row_mask:0xf bank_mask:0xf
  v_lshrrev_b32 v102, 2, v100
  s_nop 0
  v_add_u32_dpp v92, v92, v92 quad_perm:[2,3,0,1] row_mask:0xf bank_mask:0xf
  v_lshl_add_u32 v104, v92, 4, v102
  v_and_b32 v105, 0x3c, v100
  v_and_b32 v106, 3, v100
  v_lshlrev_b32 v106, 4, v106
  ds_write_b32 v105, v104 offset:2112
  ds_read_b128 v[108:111], v106 offset:2112
  v_sub_u32 v93, 0, v92
  v_and_b32 v93, 31, v93
  v_cndmask_b32 v93, 0, v93, s[72:73]
  v_add_u32 v94, v91, v93
  v_mov_b32 v103, v94
  s_nop 1
  v_add_u32_dpp v103, v103, v103 row_shr:1 row_mask:0xf bank_mask:0xf bound_ctrl:1
  s_nop 1
  v_add_u32_dpp v103, v103, v103 row_shr:2 row_mask:0xf bank_mask:0xf bound_ctrl:1
  s_nop 1
  v_add_u32_dpp v103, v103, v103 row_shr:4 row_mask:0xf bank_mask:0xf bound_ctrl:1
  s_nop 1
  v_add_u32_dpp v103, v103, v103 row_shr:8 row_mask:0xf bank_mask:0xf bound_ctrl:1
  s_nop 1
  v_add_u32_dpp v103, v103, v103 row_bcast:15 row_mask:0xa bank_mask:0xf
  s_nop 1
  v_add_u32_dpp v103, v103, v103 row_bcast:31 row_mask:0xc bank_mask:0xf
  v_sub_u32 v96, v103, v94
  v_add_u32 v97, v96, v88
  v_add_u32 v98, v96, v89
  v_add_u32 v99, v96, v90
  ds_write_b128 v101, v[96:99] offset:1024
  v_readlane_b32 s74, v103, 63
  s_nop 0
  s_cmp_le_u32 s74, 3712
  s_cbranch_scc1 K2_FITS
  s_add_u32 s53, s52, 4
  s_waitcnt lgkmcnt(0)
  s_branch K2_ROUND
K2_FITS:
  s_mov_b64 exec, s[76:77]
  s_cbranch_execz K2_BR_MID
  ds_read_b32 v16, v16 offset:1024
  s_mov_b64 exec, s[78:79]
  s_cbranch_execz K2_BR_MID
  ds_read_b32 v17, v17 offset:1024
  s_mov_b64 exec, s[80:81]
  s_cbranch_execz K2_BR_MID
  ds_read_b32 v18, v18 offset:1024
  s_mov_b64 exec, s[82:83]
  s_cbranch_execz K2_BR_MID
  ds_read_b32 v19, v19 offset:1024
K2_BR_MID:
  s_mov_b64 exec, s[84:85]
  s_cbranch_execz K2_BR_DONE
  ds_read_b32 v20, v20 offset:1024
  s_mov_b64 exec, s[86:87]
  s_cbranch_execz K2_BR_DONE
  ds_read_b32 v21, v21 offset:1024
  s_mov_b64 exec, s[88:89]
  s_cbranch_execz K2_BR_DONE
  ds_read_b32 v22, v22 offset:1024
  s_mov_b64 exec, s[90:91]
  s_cbranch_execz K2_BR_DONE
  ds_read_b32 v23, v23 offset:1024
K2_BR_DONE:
  s_mov_b64 exec, -1
  s_cmp_eq_u32 s69, 0
  s_cbranch_scc1 K2_NFG
  s_lshr_b32 s56, s48, 2
  s_and_b32 s57, s56, 1
  s_mul_i32 s57, s57, 3
  s_xor_b32 s56, s48, s57
  s_waitcnt lgkmcnt(0)
  v_cmp_gt_u32 vcc, v108, v104
  v_cmp_gt_u32 s[70:71], v109, v104
  s_nop 0
  v_addc_co_u32 v105, vcc, 0, 0, vcc
  v_addc_co_u32 v105, s[70:71], 0, v105, s[70:71]
  v_cmp_gt_u32 vcc, v110, v104
  v_cmp_gt_u32 s[70:71], v111, v104
  s_nop 0
  v_addc_co_u32 v105, vcc, 0, v105, vcc
  v_addc_co_u32 v105, s[70:71], 0, v105, s[70:71]
  s_nop 1
  v_add_u32_dpp v105, v105, v105 quad_perm:[1,0,3,2] row_mask:0xf bank_mask:0xf
  s_nop 1
  v_add_u32_dpp v105, v105, v105 quad_perm:[2,3,0,1] row_mask:0xf bank_mask:0xf
  v_cmp_eq_u32 vcc, s56, v105
  s_nop 0
  s_ff1_i32_b64 s0, vcc
  s_lshr_b32 s0, s0, 2
  s_and_b32 s0, s0, 15
  s_and_b32 s57, s0, 7
  s_cmp_eq_u32 s57, 0
  s_cselect_b32 s59, 7, 6
  s_mul_i32 s49, s0, 49
  s_add_u32 s49, s49, 7
  s_lshr_b32 s49, s49, 3
  s_mul_i32 s58, s2, 98
  s_add_u32 s58, s58, s49
  s_lshl_b32 s49, s49, 4
  s_add_u32 s49, s49, 3072
  s_sub_i32 s57, 25000, s58
  s_max_i32 s57, s57, 0
  s_min_u32 s59, s59, s57
  s_min_u32 s58, s58, 25000
  s_lshl_b32 s56, s58, 7
  s_lshl_b32 s57, s59, 7
  s_add_u32 s32, s4, s56
  s_addc_u32 s33, s5, 0
  s_mov_b32 s34, s57
  s_mov_b32 s35, 0x20000
  v_and_b32 v105, 3, v100
  v_bfe_u32 v106, v100, 3, 2
  v_lshl_add_u32 v105, v106, 2, v105
  v_lshl_add_u32 v105, v105, 7, v121
  s_mov_b32 exec_lo, 0xf0f
  s_mov_b32 exec_hi, 0xf0f
  buffer_load_dwordx4 v[32:35], v105, s[32:35], 0 offen offset:0
  buffer_load_dwordx4 v[36:39], v105, s[32:35], 0 offen offset:32
  buffer_load_dwordx4 v[40:43], v105, s[32:35], 0 offen offset:64
  buffer_load_dwordx4 v[44:47], v105, s[32:35], 0 offen offset:96
  s_mov_b64 exec, -1
  s_mov_b64 exec, -1
  v_mov_b32 v120, 2944
  v_mov_b32 v105, s49
  v_cndmask_b32 v120, v120, v105, s[64:65]
  s_add_u32 s40, s8, s56
  s_addc_u32 s41, s9, 0
  s_mov_b32 s42, s57
  s_mov_b32 s43, 0x20000
  s_mul_i32 s56, s58, 6
  s_add_u32 s56, s56, 3200000
  s_mul_i32 s57, s59, 6
  s_add_u32 s44, s8, s56
  s_addc_u32 s45, s9, 0
  s_mov_b32 s46, s57
  s_mov_b32 s47, 0x20000
K2_NFG:
  s_lshl_b32 s56, s0, 2
  v_readlane_b32 s75, v96, s56
  v_readlane_b32 s55, v92, s56
  v_mov_b32 v102, 7
  v_mov_b32 v103, 0
  s_add_u32 s57, s75, s55
  s_sub_u32 s50, 0, s55
  s_and_b32 s50, s50, 31
  v_add_lshl_u32 v101, s57, v100, 2
  v_cmp_gt_u32 vcc, s50, v100
  s_nop 0
  s_mov_b64 exec, vcc
  ds_write2st64_b32 v101, v102, v103 offset0:27 offset1:85
  s_waitcnt lgkmcnt(1)
  s_mov_b64 exec, s[76:77]
  s_cbranch_execz K2_LW_MID
  v_add_lshl_u32 v16, v16, v24, 2
  ds_write2st64_b32 v16, v0, v4 offset0:27 offset1:85
  s_mov_b64 exec, s[78:79]
  s_cbranch_execz K2_LW_MID
  v_add_lshl_u32 v17, v17, v25, 2
  ds_write2st64_b32 v17, v1, v5 offset0:27 offset1:85
  s_mov_b64 exec, s[80:81]
  s_cbranch_execz K2_LW_MID
  v_add_lshl_u32 v18, v18, v26, 2
  ds_write2st64_b32 v18, v2, v6 offset0:27 offset1:85
  s_mov_b64 exec, s[82:83]
  s_cbranch_execz K2_LW_MID
  v_add_lshl_u32 v19, v19, v27, 2
  ds_write2st64_b32 v19, v3, v7 offset0:27 offset1:85
K2_LW_MID:
  s_mov_b64 exec, s[84:85]
  s_cbranch_execz K2_LW_DONE
  v_add_lshl_u32 v20, v20, v28, 2
  ds_write2st64_b32 v20, v8, v9 offset0:27 offset1:85
  s_mov_b64 exec, s[86:87]
  s_cbranch_execz K2_LW_DONE
  v_add_lshl_u32 v21, v21, v29, 2
  ds_write2st64_b32 v21, v10, v11 offset0:27 offset1:85
  s_mov_b64 exec, s[88:89]
  s_cbranch_execz K2_LW_DONE
  v_add_lshl_u32 v22, v22, v30, 2
  ds_write2st64_b32 v22, v12, v13 offset0:27 offset1:85
  s_mov_b64 exec, s[90:91]
  s_cbranch_execz K2_LW_DONE
  v_add_lshl_u32 v23, v23, v31, 2
  ds_write2st64_b32 v23, v14, v15 offset0:27 offset1:85
K2_LW_DONE:
  s_mov_b64 exec, -1
  s_lshl_b32 s56, s75, 2
  s_add_u32 s56, s56, 6912
  v_lshrrev_b32 v101, 3, v100
  v_lshl_add_u32 v124, v101, 4, s56
  v_and_b32 v101, 31, v100
  v_lshl_add_u32 v125, v101, 2, s56
  s_add_u32 s55, s55, 31
  s_lshr_b32 s55, s55, 5
  s_waitcnt vmcnt(5) lgkmcnt(0)
  s_barrier
  s_setprio 3
  ds_read_b128 v[108:111], v124
  ds_read_b32 v122, v125
  ds_read_b32 v126, v125 offset:14848
  s_waitcnt lgkmcnt(0)
  v_and_or_b32 v108, v108, s68, v116
  v_and_or_b32 v109, v109, s68, v116
  v_and_or_b32 v110, v110, s68, v116
  v_and_or_b32 v111, v111, s68, v116
  v_add_u32 v126, v126, v121
  v_and_b32 v115, s68, v122
  v_lshrrev_b32 v115, 3, v115
  s_mov_b32 m0, s60
  v_and_b32 v122, 7, v122
  buffer_load_dwordx4 v108, s[20:23], 0 offen lds
  s_mov_b32 m0, s61
  s_nop 0
  buffer_load_dwordx4 v109, s[20:23], 0 offen lds
  s_mov_b32 m0, s62
  s_nop 0
  buffer_load_dwordx4 v110, s[20:23], 0 offen lds
  s_mov_b32 m0, s63
  s_nop 0
  buffer_load_dwordx4 v111, s[20:23], 0 offen lds
  s_mov_b64 exec, s[64:65]
  buffer_load_dwordx3 v[112:114], v115, s[28:31], 0 offen
  s_mov_b64 exec, -1
  buffer_load_dwordx4 v[104:107], v126, s[24:27], 0 offen
  v_lshl_add_u32 v115, v122, 4, v120
  ds_read_b128 v[108:111], v115
  v_add_u32 v124, 128, v124
  v_add_u32 v125, 128, v125
  s_cmp_eq_u32 s69, 0
  s_cbranch_scc1 K2_NF2
  s_mov_b32 s69, 0
  v_lshlrev_b32 v18, 4, v100
  v_add_u32 v48, 155392, v18
  v_lshlrev_b32 v19, 2, v101
  ds_read_b128 v[64:67], v18 offset:4864
  ds_read_b128 v[68:71], v18 offset:5888
  ds_read_b32 v74, v19 offset:2304
  ds_read_b32 v78, v19 offset:2432
  v_mov_b32 v16, v100
  v_mov_b32 v20, v101
  v_lshrrev_b32 v21, 5, v16
  v_and_b32 v24, 3, v16
  v_pk_mov_b32 v[28:29], 0, 0
  v_pk_mov_b32 v[30:31], 0, 0
  s_lshl_b32 s56, s48, 11
  s_add_u32 s56, s56, 36608
  v_add_u32 v18, s56, v18
  ds_write_b128 v18, v[28:31]
  ds_write_b128 v18, v[28:31] offset:1024
  ds_read_b128 v[88:91], v48 offset:0
  ds_read_b128 v[92:95], v48 offset:1024
  ds_read_b128 v[96:99], v48 offset:2048
  ds_read_b128 v[100:103], v48 offset:3072
  ds_read_b128 v[52:55], v48 offset:4096
  ds_read_b128 v[56:59], v48 offset:5120
  ds_read_b128 v[60:63], v48 offset:6144
  v_bfe_u32 v22, v16, 4, 1
  v_bfe_u32 v23, v16, 2, 2
  v_lshl_add_u32 v119, v20, 6, s56
  v_lshl_add_u32 v25, v21, 2, v23
  v_lshl_add_u32 v118, v25, 6, s56
  v_lshl_add_u32 v25, v22, 2, v24
  v_lshl_add_u32 v118, v25, 3, v118
  v_lshrrev_b32 v25, 1, v23
  v_mul_u32_u24 v117, 1088, v25
  v_and_b32 v25, 1, v23
  v_lshl_add_u32 v25, v21, 2, v25
  v_lshl_add_u32 v117, v25, 7, v117
  v_lshl_add_u32 v117, v22, 5, v117
  v_lshl_add_u32 v117, v24, 3, v117
  v_add_u32 v117, s60, v117
  v_bfe_u32 v25, v20, 1, 1
  v_bfe_u32 v26, v20, 3, 1
  v_lshl_add_u32 v25, v25, 1, v26
  v_and_b32 v26, 1, v20
  v_lshl_add_u32 v49, v25, 1, v26
  v_xor_b32 v26, v21, v22
  v_lshl_add_u32 v49, v26, 3, v49
  v_bfe_u32 v26, v20, 2, 1
  v_lshlrev_b32 v26, 4, v26
  v_mov_b32 v27, 0x3f80
  v_lshlrev_b32 v50, v26, v27
  s_waitcnt vmcnt(6)
  s_waitcnt lgkmcnt(6)
  v_mfma_f32_32x32x16_bf16 v[0:15], v[32:35], v[88:91], 0
  ds_read_b128 v[88:91], v48 offset:7168
  s_waitcnt lgkmcnt(6)
  v_mfma_f32_32x32x16_bf16 v[16:31], v[32:35], v[92:95], 0
  v_cmp_eq_u32 vcc, 0, v49
  v_cmp_eq_u32 s[70:71], 1, v49
  s_nop 0
  v_cndmask_b32 v80, 0, v50, vcc
  v_cndmask_b32 v81, 0, v50, s[70:71]
  s_waitcnt lgkmcnt(5)
  v_mfma_f32_32x32x16_bf16 v[0:15], v[36:39], v[96:99], v[0:15]
  v_cmp_eq_u32 vcc, 2, v49
  v_cmp_eq_u32 s[70:71], 3, v49
  s_nop 0
  v_cndmask_b32 v82, 0, v50, vcc
  v_cndmask_b32 v83, 0, v50, s[70:71]
  s_waitcnt lgkmcnt(4)
  v_mfma_f32_32x32x16_bf16 v[16:31], v[36:39], v[100:103], v[16:31]
  v_cmp_eq_u32 vcc, 4, v49
  v_cmp_eq_u32 s[70:71], 5, v49
  s_nop 0
  v_cndmask_b32 v84, 0, v50, vcc
  v_cndmask_b32 v85, 0, v50, s[70:71]
  s_waitcnt lgkmcnt(3)
  v_mfma_f32_32x32x16_bf16 v[0:15], v[40:43], v[52:55], v[0:15]
  v_cmp_eq_u32 vcc, 6, v49
  v_cmp_eq_u32 s[70:71], 7, v49
  s_nop 0
  v_cndmask_b32 v86, 0, v50, vcc
  v_cndmask_b32 v87, 0, v50, s[70:71]
  s_waitcnt lgkmcnt(2)
  v_mfma_f32_32x32x16_bf16 v[16:31], v[40:43], v[56:59], v[16:31]
  s_waitcnt lgkmcnt(1)
  v_mfma_f32_32x32x16_bf16 v[0:15], v[44:47], v[60:63], v[0:15]
  s_waitcnt lgkmcnt(0)
  v_mfma_f32_32x32x16_bf16 v[16:31], v[44:47], v[88:91], v[16:31]
  s_mov_b32 s70, 0xbfb8aa3b
  s_mov_b32 s71, 0xbfb8aa3b
  s_mov_b64 exec, s[64:65]
  v_mov_b32 v72, 0
  v_mov_b32 v73, 0
  v_mov_b32 v75, 0
  v_mov_b32 v76, 0
  v_mov_b32 v77, 0
  v_mov_b32 v79, 0
  s_mov_b64 exec, -1
  v_pk_mov_b32 v[88:89], 0, 0
  v_pk_mov_b32 v[90:91], 0, 0
  s_nop 1
  v_mfma_f32_32x32x16_bf16 v[32:47], v[88:91], v[88:91], 0
  v_mfma_f32_32x32x16_bf16 v[48:63], v[88:91], v[88:91], 0
  s_mov_b32 exec_hi, 0
  v_pk_mul_f32 v[0:1], v[0:1], s[70:71]
  v_pk_mul_f32 v[2:3], v[2:3], s[70:71]
  v_pk_mul_f32 v[4:5], v[4:5], s[70:71]
  v_pk_mul_f32 v[6:7], v[6:7], s[70:71]
  v_pk_mul_f32 v[16:17], v[16:17], s[70:71]
  v_pk_mul_f32 v[18:19], v[18:19], s[70:71]
  v_pk_mul_f32 v[20:21], v[20:21], s[70:71]
  v_pk_mul_f32 v[22:23], v[22:23], s[70:71]
  v_cvt_pk_bf16_f32 v72, v0, v1
  v_cvt_pk_bf16_f32 v73, v2, v3
  v_cvt_pk_bf16_f32 v74, v4, v5
  v_cvt_pk_bf16_f32 v75, v6, v7
  v_cvt_pk_bf16_f32 v76, v16, v17
  v_cvt_pk_bf16_f32 v77, v18, v19
  v_cvt_pk_bf16_f32 v78, v20, v21
  v_cvt_pk_bf16_f32 v79, v22, v23
  s_mov_b64 exec, -1
K2_NF2:
  v_mov_b32 v123, v119
  v_pk_mov_b32 v[16:17], 0, 0
  v_pk_mov_b32 v[18:19], 0, 0
  v_pk_mov_b32 v[24:25], 0, 0
  v_pk_mov_b32 v[26:27], 0, 0
  s_cmp_eq_u32 s55, 0
  s_cbranch_scc1 K2_EMPTY
  s_waitcnt vmcnt(1)
  ds_read_b64_tr_b16 v[96:97], v117 offset:0
  ds_read_b64_tr_b16 v[98:99], v117 offset:256
  ds_read_b64_tr_b16 v[100:101], v117 offset:2176
  ds_read_b64_tr_b16 v[102:103], v117 offset:2432
  s_waitcnt lgkmcnt(4)
  s_mov_b64 exec, s[64:65]
  v_sub_f32 v108, v108, v112
  v_sub_f32 v109, v109, v113
  v_sub_f32 v110, v110, v114
  v_mul_f32 v112, v108, v108
  v_fmac_f32 v112, v109, v109
  v_fmac_f32 v112, v110, v110
  v_cvt_pk_bf16_f32 v108, 1.0, v108
  v_cvt_pk_bf16_f32 v109, v109, v110
  v_cvt_pk_bf16_f32 v110, v112, v112
  s_mov_b64 exec, -1
  s_waitcnt lgkmcnt(2)
  v_mfma_f32_32x32x16_bf16 v[0:15], v[80:83], v[96:99], 0
  s_waitcnt lgkmcnt(0)
  v_mfma_f32_32x32x16_bf16 v[0:15], v[84:87], v[100:103], v[0:15]
  v_mfma_f32_32x32x16_bf16 v[0:15], v[108:111], v[72:75], v[0:15]
  s_waitcnt vmcnt(0)
  v_mfma_f32_32x32x16_bf16 v[0:15], v[104:107], v[64:67], v[0:15]
  ds_read_b64_tr_b16 v[96:97], v118 offset:0
  ds_read_b64_tr_b16 v[98:99], v118 offset:512
  ds_read_b64_tr_b16 v[100:101], v118 offset:1024
  ds_read_b64_tr_b16 v[102:103], v118 offset:1536
  s_nop 3
  s_cmp_eq_u32 s55, 1
  s_cbranch_scc1 K2_LAST
  .p2align 3
K2_TILE:
  s_waitcnt lgkmcnt(2)
  v_mfma_f32_32x32x16_bf16 v[48:63], v[16:19], v[96:99], v[48:63]
  v_exp_f32 v88, v0
  v_exp_f32 v89, v1
  v_exp_f32 v90, v2
  v_exp_f32 v91, v3
  s_waitcnt lgkmcnt(0)
  v_mfma_f32_32x32x16_bf16 v[48:63], v[24:27], v[100:103], v[48:63]
  v_exp_f32 v92, v4
  v_exp_f32 v93, v5
  v_exp_f32 v94, v6
  v_exp_f32 v95, v7
  s_mov_b64 exec, s[64:65]
  ds_write2_b32 v123, v111, v111 offset0:0 offset1:1
  v_lshl_add_u32 v123, v122, 3, v119
  ds_write_b64 v123, v[108:109]
  s_mov_b64 exec, -1
  ds_read_b64_tr_b16 v[96:97], v117 offset:64
  ds_read_b64_tr_b16 v[98:99], v117 offset:320
  ds_read_b64_tr_b16 v[100:101], v117 offset:2240
  ds_read_b64_tr_b16 v[102:103], v117 offset:2496
  v_pk_add_f32 v[88:89], v[88:89], s[66:67]
  v_pk_add_f32 v[90:91], v[90:91], s[66:67]
  v_pk_add_f32 v[92:93], v[92:93], s[66:67]
  v_pk_add_f32 v[94:95], v[94:95], s[66:67]
  v_mfma_f32_32x32x16_bf16 v[16:31], v[108:111], v[76:79], 0
  v_rcp_f32 v88, v88
  v_rcp_f32 v89, v89
  v_rcp_f32 v90, v90
  v_rcp_f32 v91, v91
  v_mfma_f32_32x32x16_bf16 v[16:31], v[104:107], v[68:71], v[16:31]
  ds_read_b128 v[108:111], v124
  ds_read_b32 v122, v125
  ds_read_b32 v126, v125 offset:14848
  v_rcp_f32 v92, v92
  v_rcp_f32 v93, v93
  v_rcp_f32 v94, v94
  v_rcp_f32 v95, v95
  v_pk_mul_f32 v[88:89], v[0:1], v[88:89]
  v_pk_mul_f32 v[90:91], v[2:3], v[90:91]
  v_pk_mul_f32 v[92:93], v[4:5], v[92:93]
  v_pk_mul_f32 v[94:95], v[6:7], v[94:95]
  v_cvt_pk_bf16_f32 v0, v88, v89
  v_cvt_pk_bf16_f32 v1, v90, v91
  v_cvt_pk_bf16_f32 v2, v92, v93
  v_cvt_pk_bf16_f32 v3, v94, v95
  s_waitcnt lgkmcnt(5)
  v_mfma_f32_32x32x16_bf16 v[16:31], v[80:83], v[96:99], v[16:31]
  v_exp_f32 v88, v8
  v_exp_f32 v89, v9
  v_exp_f32 v90, v10
  v_exp_f32 v91, v11
  s_waitcnt lgkmcnt(3)
  v_mfma_f32_32x32x16_bf16 v[16:31], v[84:87], v[100:103], v[16:31]
  v_exp_f32 v92, v12
  v_exp_f32 v93, v13
  v_exp_f32 v94, v14
  v_exp_f32 v95, v15
  s_waitcnt lgkmcnt(0)
  v_and_or_b32 v108, v108, s68, v116
  v_and_or_b32 v109, v109, s68, v116
  v_and_or_b32 v110, v110, s68, v116
  v_and_or_b32 v111, v111, s68, v116
  v_add_u32 v126, v126, v121
  v_and_b32 v115, s68, v122
  v_lshrrev_b32 v115, 3, v115
  s_mov_b32 m0, s60
  v_and_b32 v122, 7, v122
  buffer_load_dwordx4 v108, s[20:23], 0 offen lds
  s_mov_b32 m0, s61
  s_nop 0
  buffer_load_dwordx4 v109, s[20:23], 0 offen lds
  s_mov_b32 m0, s62
  s_nop 0
  buffer_load_dwordx4 v110, s[20:23], 0 offen lds
  s_mov_b32 m0, s63
  s_nop 0
  buffer_load_dwordx4 v111, s[20:23], 0 offen lds
  s_mov_b64 exec, s[64:65]
  buffer_load_dwordx3 v[112:114], v115, s[28:31], 0 offen
  s_mov_b64 exec, -1
  buffer_load_dwordx4 v[104:107], v126, s[24:27], 0 offen
  v_pk_add_f32 v[88:89], v[88:89], s[66:67]
  v_pk_add_f32 v[90:91], v[90:91], s[66:67]
  v_pk_add_f32 v[92:93], v[92:93], s[66:67]
  v_pk_add_f32 v[94:95], v[94:95], s[66:67]
  v_rcp_f32 v88, v88
  v_rcp_f32 v89, v89
  v_rcp_f32 v90, v90
  v_rcp_f32 v91, v91
  v_lshl_add_u32 v115, v122, 4, v120
  ds_read_b128 v[108:111], v115
  v_add_u32 v124, 128, v124
  v_add_u32 v125, 128, v125
  ds_read_b64_tr_b16 v[96:97], v118 offset:0
  ds_read_b64_tr_b16 v[98:99], v118 offset:512
  ds_read_b64_tr_b16 v[100:101], v118 offset:1024
  ds_read_b64_tr_b16 v[102:103], v118 offset:1536
  v_rcp_f32 v92, v92
  v_rcp_f32 v93, v93
  v_rcp_f32 v94, v94
  v_rcp_f32 v95, v95
  v_pk_mul_f32 v[88:89], v[8:9], v[88:89]
  v_pk_mul_f32 v[90:91], v[10:11], v[90:91]
  v_pk_mul_f32 v[92:93], v[12:13], v[92:93]
  v_pk_mul_f32 v[94:95], v[14:15], v[94:95]
  v_cvt_pk_bf16_f32 v8, v88, v89
  v_cvt_pk_bf16_f32 v9, v90, v91
  v_cvt_pk_bf16_f32 v10, v92, v93
  v_cvt_pk_bf16_f32 v11, v94, v95
  s_waitcnt lgkmcnt(2)
  v_mfma_f32_32x32x16_bf16 v[32:47], v[0:3], v[96:99], v[32:47]
  v_exp_f32 v88, v16
  v_exp_f32 v89, v17
  v_exp_f32 v90, v18
  v_exp_f32 v91, v19
  s_waitcnt lgkmcnt(0)
  v_mfma_f32_32x32x16_bf16 v[32:47], v[8:11], v[100:103], v[32:47]
  v_exp_f32 v92, v20
  v_exp_f32 v93, v21
  v_exp_f32 v94, v22
  v_exp_f32 v95, v23
  s_waitcnt vmcnt(1)
  ds_read_b64_tr_b16 v[96:97], v117 offset:0
  ds_read_b64_tr_b16 v[98:99], v117 offset:256
  ds_read_b64_tr_b16 v[100:101], v117 offset:2176
  ds_read_b64_tr_b16 v[102:103], v117 offset:2432
  s_mov_b64 exec, s[64:65]
  v_sub_f32 v108, v108, v112
  v_sub_f32 v109, v109, v113
  v_sub_f32 v110, v110, v114
  v_mul_f32 v112, v108, v108
  v_fmac_f32 v112, v109, v109
  v_fmac_f32 v112, v110, v110
  v_cvt_pk_bf16_f32 v108, 1.0, v108
  v_cvt_pk_bf16_f32 v109, v109, v110
  v_cvt_pk_bf16_f32 v110, v112, v112
  s_mov_b64 exec, -1
  v_pk_add_f32 v[88:89], v[88:89], s[66:67]
  v_pk_add_f32 v[90:91], v[90:91], s[66:67]
  v_pk_add_f32 v[92:93], v[92:93], s[66:67]
  v_pk_add_f32 v[94:95], v[94:95], s[66:67]
  s_waitcnt lgkmcnt(2)
  v_mfma_f32_32x32x16_bf16 v[0:15], v[80:83], v[96:99], 0
  v_rcp_f32 v88, v88
  v_rcp_f32 v89, v89
  v_rcp_f32 v90, v90
  v_rcp_f32 v91, v91
  s_waitcnt lgkmcnt(0)
  v_mfma_f32_32x32x16_bf16 v[0:15], v[84:87], v[100:103], v[0:15]
  v_rcp_f32 v92, v92
  v_rcp_f32 v93, v93
  v_rcp_f32 v94, v94
  v_rcp_f32 v95, v95
  v_pk_mul_f32 v[88:89], v[16:17], v[88:89]
  v_pk_mul_f32 v[90:91], v[18:19], v[90:91]
  v_pk_mul_f32 v[92:93], v[20:21], v[92:93]
  v_pk_mul_f32 v[94:95], v[22:23], v[94:95]
  v_cvt_pk_bf16_f32 v16, v88, v89
  v_cvt_pk_bf16_f32 v17, v90, v91
  v_cvt_pk_bf16_f32 v18, v92, v93
  v_cvt_pk_bf16_f32 v19, v94, v95
  v_mfma_f32_32x32x16_bf16 v[0:15], v[108:111], v[72:75], v[0:15]
  v_exp_f32 v88, v24
  v_exp_f32 v89, v25
  v_exp_f32 v90, v26
  v_exp_f32 v91, v27
  s_waitcnt vmcnt(0)
  v_mfma_f32_32x32x16_bf16 v[0:15], v[104:107], v[64:67], v[0:15]
  v_exp_f32 v92, v28
  v_exp_f32 v93, v29
  v_exp_f32 v94, v30
  v_exp_f32 v95, v31
  ds_read_b64_tr_b16 v[96:97], v118 offset:0
  ds_read_b64_tr_b16 v[98:99], v118 offset:512
  ds_read_b64_tr_b16 v[100:101], v118 offset:1024
  ds_read_b64_tr_b16 v[102:103], v118 offset:1536
  v_pk_add_f32 v[88:89], v[88:89], s[66:67]
  v_pk_add_f32 v[90:91], v[90:91], s[66:67]
  v_pk_add_f32 v[92:93], v[92:93], s[66:67]
  v_pk_add_f32 v[94:95], v[94:95], s[66:67]
  v_rcp_f32 v88, v88
  v_rcp_f32 v89, v89
  v_rcp_f32 v90, v90
  v_rcp_f32 v91, v91
  v_rcp_f32 v92, v92
  v_rcp_f32 v93, v93
  v_rcp_f32 v94, v94
  v_rcp_f32 v95, v95
  v_pk_mul_f32 v[88:89], v[24:25], v[88:89]
  v_pk_mul_f32 v[90:91], v[26:27], v[90:91]
  v_pk_mul_f32 v[92:93], v[28:29], v[92:93]
  v_pk_mul_f32 v[94:95], v[30:31], v[94:95]
  v_cvt_pk_bf16_f32 v24, v88, v89
  v_cvt_pk_bf16_f32 v25, v90, v91
  v_cvt_pk_bf16_f32 v26, v92, v93
  v_cvt_pk_bf16_f32 v27, v94, v95
  s_sub_u32 s55, s55, 1
  s_cmp_eq_u32 s55, 6
  s_cbranch_scc0 K2_P0
  s_setprio 2
K2_P0:
  s_cmp_eq_u32 s55, 4
  s_cbranch_scc0 K2_P1
  s_setprio 1
K2_P1:
  s_cmp_eq_u32 s55, 2
  s_cbranch_scc0 K2_P2
  s_setprio 0
K2_P2:
  s_cmp_lg_u32 s55, 1
  s_cbranch_scc1 K2_TILE
K2_LAST:
  s_cmp_ge_u32 s50, 16
  s_cbranch_scc1 K2_LASTH
  s_waitcnt lgkmcnt(2)
  v_mfma_f32_32x32x16_bf16 v[48:63], v[16:19], v[96:99], v[48:63]
  v_exp_f32 v88, v0
  v_exp_f32 v89, v1
  v_exp_f32 v90, v2
  v_exp_f32 v91, v3
  s_waitcnt lgkmcnt(0)
  v_mfma_f32_32x32x16_bf16 v[48:63], v[24:27], v[100:103], v[48:63]
  v_exp_f32 v92, v4
  v_exp_f32 v93, v5
  v_exp_f32 v94, v6
  v_exp_f32 v95, v7
  s_mov_b64 exec, s[64:65]
  ds_write2_b32 v123, v111, v111 offset0:0 offset1:1
  v_lshl_add_u32 v123, v122, 3, v119
  ds_write_b64 v123, v[108:109]
  s_mov_b64 exec, -1
  ds_read_b64_tr_b16 v[96:97], v117 offset:64
  ds_read_b64_tr_b16 v[98:99], v117 offset:320
  ds_read_b64_tr_b16 v[100:101], v117 offset:2240
  ds_read_b64_tr_b16 v[102:103], v117 offset:2496
  v_pk_add_f32 v[88:89], v[88:89], s[66:67]
  v_pk_add_f32 v[90:91], v[90:91], s[66:67]
  v_pk_add_f32 v[92:93], v[92:93], s[66:67]
  v_pk_add_f32 v[94:95], v[94:95], s[66:67]
  v_mfma_f32_32x32x16_bf16 v[16:31], v[108:111], v[76:79], 0
  v_rcp_f32 v88, v88
  v_rcp_f32 v89, v89
  v_rcp_f32 v90, v90
  v_rcp_f32 v91, v91
  v_mfma_f32_32x32x16_bf16 v[16:31], v[104:107], v[68:71], v[16:31]
  v_rcp_f32 v92, v92
  v_rcp_f32 v93, v93
  v_rcp_f32 v94, v94
  v_rcp_f32 v95, v95
  v_pk_mul_f32 v[88:89], v[0:1], v[88:89]
  v_pk_mul_f32 v[90:91], v[2:3], v[90:91]
  v_pk_mul_f32 v[92:93], v[4:5], v[92:93]
  v_pk_mul_f32 v[94:95], v[6:7], v[94:95]
  v_cvt_pk_bf16_f32 v0, v88, v89
  v_cvt_pk_bf16_f32 v1, v90, v91
  v_cvt_pk_bf16_f32 v2, v92, v93
  v_cvt_pk_bf16_f32 v3, v94, v95
  s_waitcnt lgkmcnt(2)
  v_mfma_f32_32x32x16_bf16 v[16:31], v[80:83], v[96:99], v[16:31]
  v_exp_f32 v88, v8
  v_exp_f32 v89, v9
  v_exp_f32 v90, v10
  v_exp_f32 v91, v11
  s_waitcnt lgkmcnt(0)
  v_mfma_f32_32x32x16_bf16 v[16:31], v[84:87], v[100:103], v[16:31]
  v_exp_f32 v92, v12
  v_exp_f32 v93, v13
  v_exp_f32 v94, v14
  v_exp_f32 v95, v15
  v_mbcnt_lo_u32_b32 v124, -1, 0
  v_mbcnt_hi_u32_b32 v124, -1, v124
  v_bfe_u32 v125, v124, 2, 2
  v_and_b32 v126, 1, v124
  v_lshl_add_u32 v125, v125, 1, v126
  v_lshrrev_b32 v126, 4, v124
  v_lshlrev_b32 v112, 4, v126
  v_lshl_add_u32 v112, v125, 7, v112
  v_and_b32 v124, 15, v124
  v_lshlrev_b32 v124, 3, v124
  v_lshl_add_u32 v124, v126, 8, v124
  buffer_load_dwordx4 v[104:107], v112, s[32:35], 0 offen
  buffer_load_dwordx4 v[112:115], v112, s[32:35], 0 offen offset:64
  buffer_load_dwordx2 v[126:127], v124, s[32:35], 0 offen offset:128
  buffer_load_dwordx2 v[124:125], v124, s[32:35], 0 offen
  v_pk_add_f32 v[88:89], v[88:89], s[66:67]
  v_pk_add_f32 v[90:91], v[90:91], s[66:67]
  v_pk_add_f32 v[92:93], v[92:93], s[66:67]
  v_pk_add_f32 v[94:95], v[94:95], s[66:67]
  v_rcp_f32 v88, v88
  v_rcp_f32 v89, v89
  v_rcp_f32 v90, v90
  v_rcp_f32 v91, v91
  ds_read_b64_tr_b16 v[96:97], v118 offset:0
  ds_read_b64_tr_b16 v[98:99], v118 offset:512
  ds_read_b64_tr_b16 v[100:101], v118 offset:1024
  ds_read_b64_tr_b16 v[102:103], v118 offset:1536
  v_rcp_f32 v92, v92
  v_rcp_f32 v93, v93
  v_rcp_f32 v94, v94
  v_rcp_f32 v95, v95
  v_pk_mul_f32 v[88:89], v[8:9], v[88:89]
  v_pk_mul_f32 v[90:91], v[10:11], v[90:91]
  v_pk_mul_f32 v[92:93], v[12:13], v[92:93]
  v_pk_mul_f32 v[94:95], v[14:15], v[94:95]
  v_cvt_pk_bf16_f32 v8, v88, v89
  v_cvt_pk_bf16_f32 v9, v90, v91
  v_cvt_pk_bf16_f32 v10, v92, v93
  v_cvt_pk_bf16_f32 v11, v94, v95
  s_waitcnt lgkmcnt(2)
  v_mfma_f32_32x32x16_bf16 v[32:47], v[0:3], v[96:99], v[32:47]
  v_exp_f32 v88, v16
  v_exp_f32 v89, v17
  v_exp_f32 v90, v18
  v_exp_f32 v91, v19
  s_waitcnt lgkmcnt(0)
  v_mfma_f32_32x32x16_bf16 v[32:47], v[8:11], v[100:103], v[32:47]
  v_exp_f32 v92, v20
  v_exp_f32 v93, v21
  v_exp_f32 v94, v22
  v_exp_f32 v95, v23
  v_pk_add_f32 v[88:89], v[88:89], s[66:67]
  v_pk_add_f32 v[90:91], v[90:91], s[66:67]
  v_pk_add_f32 v[92:93], v[92:93], s[66:67]
  v_pk_add_f32 v[94:95], v[94:95], s[66:67]
  v_rcp_f32 v88, v88
  v_rcp_f32 v89, v89
  v_rcp_f32 v90, v90
  v_rcp_f32 v91, v91
  v_rcp_f32 v92, v92
  v_rcp_f32 v93, v93
  v_rcp_f32 v94, v94
  v_rcp_f32 v95, v95
  v_pk_mul_f32 v[88:89], v[16:17], v[88:89]
  v_pk_mul_f32 v[90:91], v[18:19], v[90:91]
  v_pk_mul_f32 v[92:93], v[20:21], v[92:93]
  v_pk_mul_f32 v[94:95], v[22:23], v[94:95]
  v_cvt_pk_bf16_f32 v16, v88, v89
  v_cvt_pk_bf16_f32 v17, v90, v91
  v_cvt_pk_bf16_f32 v18, v92, v93
  v_cvt_pk_bf16_f32 v19, v94, v95
  s_nop 1
  v_mfma_f32_32x32x16_bf16 v[48:63], v[16:19], v[96:99], v[48:63]
  v_exp_f32 v88, v24
  v_exp_f32 v89, v25
  v_exp_f32 v90, v26
  v_exp_f32 v91, v27
  v_exp_f32 v92, v28
  v_exp_f32 v93, v29
  v_exp_f32 v94, v30
  v_exp_f32 v95, v31
  v_pk_add_f32 v[88:89], v[88:89], s[66:67]
  v_pk_add_f32 v[90:91], v[90:91], s[66:67]
  v_pk_add_f32 v[92:93], v[92:93], s[66:67]
  v_pk_add_f32 v[94:95], v[94:95], s[66:67]
  v_rcp_f32 v88, v88
  v_rcp_f32 v89, v89
  v_rcp_f32 v90, v90
  v_rcp_f32 v91, v91
  v_rcp_f32 v92, v92
  v_rcp_f32 v93, v93
  v_rcp_f32 v94, v94
  v_rcp_f32 v95, v95
  v_pk_mul_f32 v[88:89], v[24:25], v[88:89]
  v_pk_mul_f32 v[90:91], v[26:27], v[90:91]
  v_pk_mul_f32 v[92:93], v[28:29], v[92:93]
  v_pk_mul_f32 v[94:95], v[30:31], v[94:95]
  v_cvt_pk_bf16_f32 v24, v88, v89
  v_cvt_pk_bf16_f32 v25, v90, v91
  v_cvt_pk_bf16_f32 v26, v92, v93
  v_cvt_pk_bf16_f32 v27, v94, v95
  s_nop 1
  v_mfma_f32_32x32x16_bf16 v[48:63], v[24:27], v[100:103], v[48:63]
  s_branch K2_TAIL
K2_LASTH:
  s_waitcnt lgkmcnt(2)
  v_mfma_f32_32x32x16_bf16 v[48:63], v[16:19], v[96:99], v[48:63]
  v_exp_f32 v88, v0
  v_exp_f32 v89, v1
  v_exp_f32 v90, v2
  v_exp_f32 v91, v3
  s_waitcnt lgkmcnt(0)
  v_mfma_f32_32x32x16_bf16 v[48:63], v[24:27], v[100:103], v[48:63]
  v_exp_f32 v92, v4
  v_exp_f32 v93, v5
  v_exp_f32 v94, v6
  v_exp_f32 v95, v7
  s_mov_b64 exec, s[64:65]
  ds_write2_b32 v123, v111, v111 offset0:0 offset1:1
  v_lshl_add_u32 v123, v122, 3, v119
  ds_write_b64 v123, v[108:109]
  s_mov_b64 exec, -1
  ds_read_b64_tr_b16 v[96:97], v117 offset:64
  ds_read_b64_tr_b16 v[98:99], v117 offset:320
  ds_read_b64_tr_b16 v[100:101], v117 offset:2240
  ds_read_b64_tr_b16 v[102:103], v117 offset:2496
  v_pk_add_f32 v[88:89], v[88:89], s[66:67]
  v_pk_add_f32 v[90:91], v[90:91], s[66:67]
  v_pk_add_f32 v[92:93], v[92:93], s[66:67]
  v_pk_add_f32 v[94:95], v[94:95], s[66:67]
  v_mfma_f32_32x32x16_bf16 v[16:31], v[108:111], v[76:79], 0
  v_rcp_f32 v88, v88
  v_rcp_f32 v89, v89
  v_rcp_f32 v90, v90
  v_rcp_f32 v91, v91
  v_mfma_f32_32x32x16_bf16 v[16:31], v[104:107], v[68:71], v[16:31]
  v_rcp_f32 v92, v92
  v_rcp_f32 v93, v93
  v_rcp_f32 v94, v94
  v_rcp_f32 v95, v95
  v_pk_mul_f32 v[88:89], v[0:1], v[88:89]
  v_pk_mul_f32 v[90:91], v[2:3], v[90:91]
  v_pk_mul_f32 v[92:93], v[4:5], v[92:93]
  v_pk_mul_f32 v[94:95], v[6:7], v[94:95]
  v_cvt_pk_bf16_f32 v0, v88, v89
  v_cvt_pk_bf16_f32 v1, v90, v91
  v_cvt_pk_bf16_f32 v2, v92, v93
  v_cvt_pk_bf16_f32 v3, v94, v95
  s_waitcnt lgkmcnt(2)
  v_mfma_f32_32x32x16_bf16 v[16:31], v[80:83], v[96:99], v[16:31]
  v_mbcnt_lo_u32_b32 v124, -1, 0
  v_mbcnt_hi_u32_b32 v124, -1, v124
  v_bfe_u32 v125, v124, 2, 2
  v_and_b32 v126, 1, v124
  v_lshl_add_u32 v125, v125, 1, v126
  v_lshrrev_b32 v126, 4, v124
  v_lshlrev_b32 v112, 4, v126
  v_lshl_add_u32 v112, v125, 7, v112
  v_and_b32 v124, 15, v124
  v_lshlrev_b32 v124, 3, v124
  v_lshl_add_u32 v124, v126, 8, v124
  buffer_load_dwordx4 v[104:107], v112, s[32:35], 0 offen
  buffer_load_dwordx4 v[112:115], v112, s[32:35], 0 offen offset:64
  buffer_load_dwordx2 v[126:127], v124, s[32:35], 0 offen offset:128
  buffer_load_dwordx2 v[124:125], v124, s[32:35], 0 offen
  s_waitcnt lgkmcnt(0)
  v_mfma_f32_32x32x16_bf16 v[16:31], v[84:87], v[100:103], v[16:31]
  ds_read_b64_tr_b16 v[96:97], v118 offset:0
  ds_read_b64_tr_b16 v[98:99], v118 offset:512
  s_waitcnt lgkmcnt(0)
  v_mfma_f32_32x32x16_bf16 v[32:47], v[0:3], v[96:99], v[32:47]
  s_nop 7
  v_exp_f32 v88, v16
  v_exp_f32 v89, v17
  v_exp_f32 v90, v18
  v_exp_f32 v91, v19
  v_exp_f32 v92, v20
  v_exp_f32 v93, v21
  v_exp_f32 v94, v22
  v_exp_f32 v95, v23
  v_pk_add_f32 v[88:89], v[88:89], s[66:67]
  v_pk_add_f32 v[90:91], v[90:91], s[66:67]
  v_pk_add_f32 v[92:93], v[92:93], s[66:67]
  v_pk_add_f32 v[94:95], v[94:95], s[66:67]
  v_rcp_f32 v88, v88
  v_rcp_f32 v89, v89
  v_rcp_f32 v90, v90
  v_rcp_f32 v91, v91
  v_rcp_f32 v92, v92
  v_rcp_f32 v93, v93
  v_rcp_f32 v94, v94
  v_rcp_f32 v95, v95
  v_pk_mul_f32 v[88:89], v[16:17], v[88:89]
  v_pk_mul_f32 v[90:91], v[18:19], v[90:91]
  v_pk_mul_f32 v[92:93], v[20:21], v[92:93]
  v_pk_mul_f32 v[94:95], v[22:23], v[94:95]
  v_cvt_pk_bf16_f32 v16, v88, v89
  v_cvt_pk_bf16_f32 v17, v90, v91
  v_cvt_pk_bf16_f32 v18, v92, v93
  v_cvt_pk_bf16_f32 v19, v94, v95
  s_nop 1
  v_mfma_f32_32x32x16_bf16 v[48:63], v[16:19], v[96:99], v[48:63]
K2_TAIL:
  s_mov_b64 exec, s[64:65]
  ds_write2_b32 v123, v111, v111 offset0:0 offset1:1
  s_mov_b64 exec, -1
  s_branch K2_RND_END
K2_EMPTY:
  s_waitcnt vmcnt(0) lgkmcnt(0)
  v_mbcnt_lo_u32_b32 v124, -1, 0
  v_mbcnt_hi_u32_b32 v124, -1, v124
  v_bfe_u32 v125, v124, 2, 2
  v_and_b32 v126, 1, v124
  v_lshl_add_u32 v125, v125, 1, v126
  v_lshrrev_b32 v126, 4, v124
  v_lshlrev_b32 v112, 4, v126
  v_lshl_add_u32 v112, v125, 7, v112
  v_and_b32 v124, 15, v124
  v_lshlrev_b32 v124, 3, v124
  v_lshl_add_u32 v124, v126, 8, v124
  buffer_load_dwordx4 v[104:107], v112, s[32:35], 0 offen
  buffer_load_dwordx4 v[112:115], v112, s[32:35], 0 offen offset:64
  buffer_load_dwordx2 v[126:127], v124, s[32:35], 0 offen offset:128
  buffer_load_dwordx2 v[124:125], v124, s[32:35], 0 offen
K2_RND_END:
  s_waitcnt lgkmcnt(0)
  s_cmp_ge_u32 s53, 16
  s_cbranch_scc1 K2_NEXTLAYER
  s_mov_b32 s52, s53
  s_add_u32 s53, s53, 4
  s_branch K2_ROUND
K2_NEXTLAYER:
  s_add_u32 s51, s51, 1
  s_mov_b32 s52, 0
  s_lshl_b32 s56, s51, 5
  s_cmp_lt_u32 s56, s54
  s_cbranch_scc1 K2_ROUND
  v_mbcnt_lo_u32_b32 v31, -1, 0
  v_mbcnt_hi_u32_b32 v31, -1, v31
  v_lshlrev_b32 v28, 4, v31
  v_add_u32 v28, 139008, v28
  ds_read_b128 v[64:67], v28 offset:0
  ds_read_b128 v[68:71], v28 offset:1024
  ds_read_b128 v[72:75], v28 offset:2048
  ds_read_b128 v[76:79], v28 offset:3072
  ds_read_b128 v[80:83], v28 offset:4096
  ds_read_b128 v[84:87], v28 offset:5120
  ds_read_b128 v[88:91], v28 offset:6144
  ds_read_b128 v[92:95], v28 offset:7168
  ds_read_b128 v[96:99], v28 offset:8192
  ds_read_b128 v[100:103], v28 offset:9216
  ds_read_b128 v[0:3], v28 offset:10240
  ds_read_b128 v[4:7], v28 offset:11264
  v_and_b32 v12, 15, v31
  v_lshrrev_b32 v13, 4, v31
  v_lshrrev_b32 v14, 2, v12
  v_and_b32 v15, 1, v31
  v_lshl_add_u32 v14, v14, 1, v15
  v_lshlrev_b32 v29, 8, v13
  v_lshl_add_u32 v29, v12, 3, v29
  s_waitcnt lgkmcnt(6)
  ds_read_b128 v[8:11], v28 offset:12288
  ds_read_b128 v[116:119], v28 offset:13312
  ds_read_b128 v[108:111], v28 offset:14336
  ds_read_b128 v[120:123], v28 offset:15360
  v_mul_u32_u24 v30, 144, v14
  v_lshl_add_u32 v30, v13, 4, v30
  v_add_u32 v30, s60, v30
  v_lshrrev_b32 v13, 5, v31
  v_lshlrev_b32 v28, 7, v13
  v_and_b32 v12, 3, v31
  v_cmp_eq_u32 vcc, 0, v12
  v_mov_b32 v14, 256
  s_nop 0
  v_cndmask_b32 v28, v28, v14, vcc
  s_mov_b64 s[76:77], vcc
  ds_read_b128 v[12:15], v28 offset:2560
  ds_read_b128 v[16:19], v28 offset:2576
  ds_read_b128 v[20:23], v28 offset:2592
  ds_read_b128 v[24:27], v28 offset:2608
  s_waitcnt lgkmcnt(0)
  v_pk_mul_f32 v[32:33], v[32:33], v[12:13]
  v_pk_mul_f32 v[34:35], v[34:35], v[14:15]
  v_pk_mul_f32 v[36:37], v[36:37], v[16:17]
  v_pk_mul_f32 v[38:39], v[38:39], v[18:19]
  v_pk_mul_f32 v[40:41], v[40:41], v[20:21]
  v_pk_mul_f32 v[42:43], v[42:43], v[22:23]
  v_pk_mul_f32 v[44:45], v[44:45], v[24:25]
  v_pk_mul_f32 v[46:47], v[46:47], v[26:27]
  ds_read_b128 v[12:15], v28 offset:2624
  ds_read_b128 v[16:19], v28 offset:2640
  ds_read_b128 v[20:23], v28 offset:2656
  ds_read_b128 v[24:27], v28 offset:2672
  s_waitcnt lgkmcnt(0)
  v_pk_mul_f32 v[48:49], v[48:49], v[12:13]
  v_pk_mul_f32 v[50:51], v[50:51], v[14:15]
  v_pk_mul_f32 v[52:53], v[52:53], v[16:17]
  v_pk_mul_f32 v[54:55], v[54:55], v[18:19]
  v_pk_mul_f32 v[56:57], v[56:57], v[20:21]
  v_pk_mul_f32 v[58:59], v[58:59], v[22:23]
  v_pk_mul_f32 v[60:61], v[60:61], v[24:25]
  v_pk_mul_f32 v[62:63], v[62:63], v[26:27]
  v_bfe_u32 v12, v31, 2, 3
  v_mul_u32_u24 v28, 144, v12
  v_lshrrev_b32 v13, 5, v31
  v_lshl_add_u32 v28, v13, 3, v28
  v_add_u32 v28, s60, v28
  v_and_b32 v14, 3, v31
  v_lshlrev_b32 v15, 4, v12
  v_lshl_add_u32 v15, v14, 2, v15
  s_sub_u32 s57, s49, 4
  v_add_u32 v15, s57, v15
  ds_read_b32 v16, v15
  v_mul_u32_u24 v12, 6, v12
  v_lshl_add_u32 v12, v14, 1, v12
  v_subrev_u32 v12, 2, v12
  s_mov_b64 exec, s[76:77]
  v_cvt_pk_bf16_f32 v32, v32, v33
  v_cvt_pk_bf16_f32 v33, v34, v35
  ds_write_b64 v28, v[32:33] offset:0
  v_cvt_pk_bf16_f32 v36, v36, v37
  v_cvt_pk_bf16_f32 v37, v38, v39
  ds_write_b64 v28, v[36:37] offset:16
  v_cvt_pk_bf16_f32 v40, v40, v41
  v_cvt_pk_bf16_f32 v41, v42, v43
  ds_write_b64 v28, v[40:41] offset:32
  v_cvt_pk_bf16_f32 v44, v44, v45
  v_cvt_pk_bf16_f32 v45, v46, v47
  ds_write_b64 v28, v[44:45] offset:48
  v_cvt_pk_bf16_f32 v48, v48, v49
  v_cvt_pk_bf16_f32 v49, v50, v51
  ds_write_b64 v28, v[48:49] offset:64
  v_cvt_pk_bf16_f32 v52, v52, v53
  v_cvt_pk_bf16_f32 v53, v54, v55
  ds_write_b64 v28, v[52:53] offset:80
  v_cvt_pk_bf16_f32 v56, v56, v57
  v_cvt_pk_bf16_f32 v57, v58, v59
  ds_write_b64 v28, v[56:57] offset:96
  v_cvt_pk_bf16_f32 v60, v60, v61
  v_cvt_pk_bf16_f32 v61, v62, v63
  ds_write_b64 v28, v[60:61] offset:112
  s_not_b64 exec, exec
  v_pk_add_f32 v[32:33], v[32:33], v[48:49]
  v_pk_add_f32 v[34:35], v[34:35], v[50:51]
  v_pk_add_f32 v[36:37], v[36:37], v[52:53]
  v_pk_add_f32 v[38:39], v[38:39], v[54:55]
  v_pk_add_f32 v[40:41], v[40:41], v[56:57]
  v_pk_add_f32 v[42:43], v[42:43], v[58:59]
  v_pk_add_f32 v[44:45], v[44:45], v[60:61]
  v_pk_add_f32 v[46:47], v[46:47], v[62:63]
  v_pk_add_f32 v[32:33], v[32:33], v[40:41]
  v_pk_add_f32 v[34:35], v[34:35], v[42:43]
  v_pk_add_f32 v[36:37], v[36:37], v[44:45]
  v_pk_add_f32 v[38:39], v[38:39], v[46:47]
  v_pk_add_f32 v[32:33], v[32:33], v[36:37]
  v_pk_add_f32 v[34:35], v[34:35], v[38:39]
  v_pk_add_f32 v[32:33], v[32:33], v[34:35]
  v_add_f32 v32, v32, v33
  s_mov_b64 exec, -1
  v_mov_b32 v33, v32
  s_nop 1
  v_permlane32_swap_b32 v32, v33
  v_add_f32 v32, v32, v33
  s_waitcnt lgkmcnt(0)
  v_add_f32 v32, v32, v16
  v_cvt_pk_bf16_f32 v32, v32, v32
  s_mov_b32 exec_lo, 0xeeeeeeee
  s_mov_b32 exec_hi, 0
  buffer_store_short v32, v12, s[44:47], 0 offen
  s_mov_b64 exec, -1
  ds_read_b128 v[36:39], v30
  ds_read_b128 v[40:43], v30 offset:64
  s_waitcnt vmcnt(1)
  v_mfma_f32_16x16x32_bf16 v[44:47], v[104:107], v[64:67], 0
  v_mfma_f32_16x16x32_bf16 v[48:51], v[104:107], v[68:71], 0
  v_mfma_f32_16x16x32_bf16 v[52:55], v[104:107], v[72:75], 0
  v_mfma_f32_16x16x32_bf16 v[56:59], v[104:107], v[76:79], 0
  v_mfma_f32_16x16x32_bf16 v[44:47], v[112:115], v[80:83], v[44:47]
  v_mfma_f32_16x16x32_bf16 v[48:51], v[112:115], v[84:87], v[48:51]
  v_mfma_f32_16x16x32_bf16 v[52:55], v[112:115], v[88:91], v[52:55]
  v_mfma_f32_16x16x32_bf16 v[56:59], v[112:115], v[92:95], v[56:59]
  s_waitcnt lgkmcnt(0)
  v_mfma_f32_16x16x32_bf16 v[44:47], v[36:39], v[96:99], v[44:47]
  v_mfma_f32_16x16x32_bf16 v[48:51], v[36:39], v[100:103], v[48:51]
  v_mfma_f32_16x16x32_bf16 v[52:55], v[36:39], v[0:3], v[52:55]
  v_mfma_f32_16x16x32_bf16 v[56:59], v[36:39], v[4:7], v[56:59]
  v_mfma_f32_16x16x32_bf16 v[44:47], v[40:43], v[8:11], v[44:47]
  v_mfma_f32_16x16x32_bf16 v[48:51], v[40:43], v[116:119], v[48:51]
  v_mfma_f32_16x16x32_bf16 v[52:55], v[40:43], v[108:111], v[52:55]
  v_mfma_f32_16x16x32_bf16 v[56:59], v[40:43], v[120:123], v[56:59]
  v_lshlrev_b32 v12, 16, v124
  v_and_b32 v13, 0xffff0000, v124
  v_lshlrev_b32 v14, 16, v125
  v_and_b32 v15, 0xffff0000, v125
  v_lshlrev_b32 v16, 16, v126
  v_and_b32 v17, 0xffff0000, v126
  v_lshlrev_b32 v18, 16, v127
  v_and_b32 v19, 0xffff0000, v127
  v_mul_f32 v20, 0xbfb8aa3b, v44
  v_mul_f32 v21, 0xbfb8aa3b, v48
  v_mul_f32 v22, 0xbfb8aa3b, v52
  v_mul_f32 v23, 0xbfb8aa3b, v56
  v_mul_f32 v24, 0xbfb8aa3b, v45
  v_mul_f32 v25, 0xbfb8aa3b, v49
  v_mul_f32 v26, 0xbfb8aa3b, v53
  v_mul_f32 v27, 0xbfb8aa3b, v57
  v_exp_f32 v20, v20
  v_exp_f32 v21, v21
  v_exp_f32 v22, v22
  v_exp_f32 v23, v23
  v_exp_f32 v24, v24
  v_exp_f32 v25, v25
  v_exp_f32 v26, v26
  v_exp_f32 v27, v27
  v_add_f32 v20, 1.0, v20
  v_add_f32 v21, 1.0, v21
  v_add_f32 v22, 1.0, v22
  v_add_f32 v23, 1.0, v23
  v_add_f32 v24, 1.0, v24
  v_add_f32 v25, 1.0, v25
  v_add_f32 v26, 1.0, v26
  v_add_f32 v27, 1.0, v27
  v_rcp_f32 v20, v20
  v_rcp_f32 v21, v21
  v_rcp_f32 v22, v22
  v_rcp_f32 v23, v23
  v_rcp_f32 v24, v24
  v_rcp_f32 v25, v25
  v_rcp_f32 v26, v26
  v_rcp_f32 v27, v27
  v_fmac_f32 v12, v20, v44
  v_fmac_f32 v13, v21, v48
  v_fmac_f32 v14, v22, v52
  v_fmac_f32 v15, v23, v56
  v_fmac_f32 v16, v24, v45
  v_fmac_f32 v17, v25, v49
  v_fmac_f32 v18, v26, v53
  v_fmac_f32 v19, v27, v57
  v_cvt_pk_bf16_f32 v20, v12, v13
  v_cvt_pk_bf16_f32 v21, v14, v15
  buffer_store_dwordx2 v[20:21], v29, s[40:43], 0 offen offset:0 sc1
  v_cvt_pk_bf16_f32 v22, v16, v17
  v_cvt_pk_bf16_f32 v23, v18, v19
  buffer_store_dwordx2 v[22:23], v29, s[40:43], 0 offen offset:128 sc1
K2_END:
  s_endpgm
.section .rodata,"a"
.p2align 6
.amdhsa_kernel egnn_part_kernel
  .amdhsa_next_free_vgpr 128
  .amdhsa_next_free_sgpr 90
  .amdhsa_accum_offset 128
  .amdhsa_group_segment_fixed_size 0
  .amdhsa_kernarg_size 88
  .amdhsa_user_sgpr_count 2
  .amdhsa_user_sgpr_kernarg_segment_ptr 1
  .amdhsa_system_sgpr_workgroup_id_x 1
  .amdhsa_float_denorm_mode_32 3
.end_amdhsa_kernel
.p2align 6
.amdhsa_kernel egnn_main_kernel
  .amdhsa_next_free_vgpr 128
  .amdhsa_next_free_sgpr 97
  .amdhsa_accum_offset 128
  .amdhsa_group_segment_fixed_size 0
  .amdhsa_kernarg_size 88
  .amdhsa_user_sgpr_count 2
  .amdhsa_user_sgpr_kernarg_segment_ptr 1
  .amdhsa_system_sgpr_workgroup_id_x 1
  .amdhsa_float_denorm_mode_32 3
.end_amdhsa_kernel
```
